```python
import torch

def _softmax(x, axis=-1):
    return torch.softmax(x, dim=axis)
def _gelu(x):
    return torch.nn.functional.gelu(x, approximate="tanh")
def _silu(x):
    return torch.nn.functional.silu(x)
def _sigmoid(x):
    return torch.sigmoid(x)
def _layernorm(x, axis=-1, eps=1e-5):
    m = x.mean(dim=axis, keepdim=True)
    v = x.var(dim=axis, keepdim=True, unbiased=False)
    return (x - m) / torch.sqrt(v + eps)
def _scatter_add(tgt, idx, src, axis=0):
    return tgt.clone().index_add_(axis, idx, src)
def _segment_sum(src, seg, n):
    out = torch.zeros((n,) + src.shape[1:], dtype=src.dtype)
    return out.index_add_(0, seg, src)
def _pad(x, pw):
    flat = tuple(v for pair in reversed(pw) for v in pair)
    return torch.nn.functional.pad(x, flat)

kernel_name = 'gated_mix__linear_attn_block__sliding_block__prompt'

def setup_inputs():

    _w = (lambda a: (lambda t: t.to(torch.bfloat16) if t.is_floating_point() else t)(torch.as_tensor(a)))
    def _A_setup():
        B, S, D = 1, 2048, 1024
        return {
            "x": _w((lambda *s: torch.randn(*s, dtype=torch.bfloat16) * 0.05)(B, S, D)),
            "wqkv": _w((lambda *s: torch.randn(*s, dtype=torch.bfloat16) * 1.6)(D, 3 * D)),
            "wo": _w((lambda *s: torch.randn(*s, dtype=torch.bfloat16) * 0.4)(D, D)),
        }
    _A_in = _A_setup()

    def _B_setup():
        B, S, D = 1, 2048, 1024
        return {
            "x": _w((lambda *s: torch.randn(*s, dtype=torch.bfloat16) * 0.05)(B, S, D)),
            "wqkv": _w((lambda *s: torch.randn(*s, dtype=torch.bfloat16) * 0.8)(D, 3 * D)),
            "wo": _w((lambda *s: torch.randn(*s, dtype=torch.bfloat16) * 0.05)(D, D)),
        }
    _B_in = _B_setup()

    return {
        "A_x": _A_in["x"],
        "A_wqkv": _A_in["wqkv"],
        "A_wo": _A_in["wo"],
        "B_x": _B_in["x"],
        "B_wqkv": _B_in["wqkv"],
        "B_wo": _B_in["wo"],
        "gate_w": _w((lambda *s: torch.randn(*s, dtype=torch.bfloat16) * 0.05)(1024) * 16.0),
    }

def reference(A_x, A_wqkv, A_wo, B_x, B_wqkv, B_wo, gate_w):
    def _A_ref(x, wqkv, wo):
        B, S, D = x.shape
        H = 32; Dh = D // H
        qkv = (lambda x, *d: x.permute(*d))((x @ wqkv).reshape(B, S, 3, H, Dh), 2, 0, 3, 1, 4)
        q, k, v = qkv[0], qkv[1], qkv[2]
        phi = lambda t: torch.where(t > 0, t + 1, torch.exp(t)) + 1e-6
        pq, pk = phi(q), phi(k)
        kv = torch.einsum("bhsd,bhse->bhde", pk, v)
        z = torch.einsum("bhsd->bhd", pk)
        num = torch.einsum("bhqd,bhde->bhqe", pq, kv)
        den = torch.einsum("bhqd,bhd->bhq", pq, z)[..., None] + 1e-6
        o = num / den
        return (lambda x, *d: x.permute(*d))(o, 0, 2, 1, 3).reshape(B, S, D) @ wo

    def _B_ref(x, wqkv, wo):
        B, S, D = x.shape
        H = 32; Dh = D // H; W = 256
        qkv = (lambda x, *d: x.permute(*d))((x @ wqkv).reshape(B, S, 3, H, Dh), 2, 0, 3, 1, 4)
        q, k, v = qkv[0], qkv[1], qkv[2]
        scores = torch.einsum("bhqd,bhkd->bhqk", q, k) * (Dh ** -0.5)
        idx = torch.arange(S)
        mask = (idx[:, None] - idx[None, :] >= 0) & (idx[:, None] - idx[None, :] < W)
        scores = torch.where(mask[None, None], scores, -1e9)
        p = _softmax(scores, axis=-1)
        o = torch.einsum("bhqk,bhkd->bhqd", p, v)
        return (lambda x, *d: x.permute(*d))(o, 0, 2, 1, 3).reshape(B, S, D) @ wo

    x = A_x
    g = _sigmoid((x * gate_w).sum(-1, keepdims=True))
    a = _A_ref(x, A_wqkv, A_wo)
    b = _B_ref(x, B_wqkv, B_wo)
    return g * a + (1 - g) * b
```

```asm
; @launch grid=(256,1,1) block=(512,1,1) lds=163840
.amdgcn_target "amdgcn-amd-amdhsa--gfx950"
.text
.globl gated_mix__linear_attn_block__sliding_block__prompt_kernel
.p2align 8
.type gated_mix__linear_attn_block__sliding_block__prompt_kernel,@function
gated_mix__linear_attn_block__sliding_block__prompt_kernel:
  s_cmp_ge_u32 s2, 256
  s_cbranch_scc1 L1_end

  s_load_dwordx16 s[4:19], s[0:1], 0
  s_load_dwordx4 s[20:23], s[0:1], 64
  v_lshrrev_b32 v1, 6, v0

  s_getpc_b64 s[68:69]
L_pc0:
  s_and_b32 s46, s2, 0xf8
  v_add_lshl_u32 v2, v1, s46, 7
  v_min_u32 v2, L_code_end-L_pc0-4, v2
  global_load_dword v254, v2, s[68:69]

  s_and_b32 s44, s2, 7
  s_lshr_b32 s45, s2, 3
  v_readfirstlane_b32 s40, v1
  s_lshr_b32 s41, s45, 2
  s_and_b32 s43, s45, 1
  s_bfe_u32 s42, s45, 0x10001
  s_lshl_b32 s46, s44, 1
  s_add_u32 s42, s42, s46
  v_and_b32 v0, 63, v0
  s_mov_b32 s26, 0x400000
  s_mov_b32 s27, 0x20000
  s_mov_b32 s30, 0x600000
  s_mov_b32 s31, s27

  s_and_b32 s46, s40, 3
  v_lshrrev_b32 v1, 3, v0
  v_and_b32 v2, 7, v0
  v_and_b32 v3, 2, v1
  v_xor_b32 v3, v2, v3
  v_lshlrev_b32 v3, 4, v3
  v_mul_u32_u24 v4, 6144, v1
  s_lshl_b32 s47, s42, 7
  s_mul_i32 s48, s46, 98304
  s_add_u32 s47, s47, s48
  v_add3_u32 v20, v4, v3, s47
  v_xor_b32 v21, 64, v20
  v_add_u32 v21, 48128, v21
  v_lshrrev_b32 v3, 1, v1
  v_xor_b32 v3, v2, v3
  v_lshlrev_b32 v3, 4, v3
  s_lshl_b32 s47, s41, 8
  s_lshl_b32 s48, s46, 6
  s_add_u32 s47, s47, s48
  v_add_u32 v4, s47, v1
  v_lshl_add_u32 v10, v4, 11, v3
  v_xor_b32 v11, 64, v10

  v_add_u32 v13, 46080, v11
  v_add_u32 v12, 30720, v10
  v_add_u32 v11, 15360, v11
  s_lshl_b32 s54, s46, 13
  s_lshl_b32 s55, s46, 11
  s_add_u32 s55, s55, 98304
  v_mov_b32 v252, v0

  s_waitcnt lgkmcnt(0)
  s_mov_b32 s24, s4
  s_and_b32 s25, s5, 0xffff
  s_cmp_eq_u32 s43, 0
  s_cselect_b32 s28, s6, s12
  s_cselect_b32 s29, s7, s13
  s_and_b32 s29, s29, 0xffff

  s_cmp_ge_u32 s40, 4
  s_cbranch_scc1 L_producer
  s_add_u32 m0, s55, 0
  s_add_u32 s48, 0, 0
  buffer_load_dwordx4 v20, s[28:31], s48 offen  lds
  buffer_load_dwordx4 v21, s[28:31], s48 offen offset:1024  lds
  s_add_u32 m0, s55, 8192
  s_add_u32 s48, 0, 2048
  buffer_load_dwordx4 v20, s[28:31], s48 offen  lds
  buffer_load_dwordx4 v21, s[28:31], s48 offen offset:1024  lds
  s_add_u32 m0, s55, 16384
  s_add_u32 s48, 0, 4096
  buffer_load_dwordx4 v20, s[28:31], s48 offen  lds
  buffer_load_dwordx4 v21, s[28:31], s48 offen offset:1024  lds
  s_cmp_eq_u32 s43, 0
  s_cselect_b32 s46, 1.0, 0
  .p2align 3
  v_pk_mul_f32 v[24:25], s[46:47], 1.0 op_sel_hi:[0,0]
  v_pk_mul_f32 v[26:27], s[46:47], 1.0 op_sel_hi:[0,0]
  v_pk_mul_f32 v[28:29], s[46:47], 1.0 op_sel_hi:[0,0]
  v_pk_mul_f32 v[30:31], s[46:47], 1.0 op_sel_hi:[0,0]
  v_pk_mul_f32 v[32:33], s[46:47], 1.0 op_sel_hi:[0,0]
  v_pk_mul_f32 v[34:35], s[46:47], 1.0 op_sel_hi:[0,0]
  v_pk_mul_f32 v[36:37], s[46:47], 1.0 op_sel_hi:[0,0]
  v_pk_mul_f32 v[38:39], s[46:47], 1.0 op_sel_hi:[0,0]
  v_pk_mul_f32 v[40:41], s[46:47], 0 op_sel_hi:[0,0]
  v_pk_mul_f32 v[42:43], s[46:47], 0 op_sel_hi:[0,0]
  v_pk_mul_f32 v[44:45], s[46:47], 0 op_sel_hi:[0,0]
  v_pk_mul_f32 v[46:47], s[46:47], 0 op_sel_hi:[0,0]
  v_pk_mul_f32 v[48:49], s[46:47], 1.0 op_sel_hi:[0,0]
  v_pk_mul_f32 v[50:51], s[46:47], 1.0 op_sel_hi:[0,0]
  v_pk_mul_f32 v[52:53], s[46:47], 1.0 op_sel_hi:[0,0]
  v_pk_mul_f32 v[54:55], s[46:47], 1.0 op_sel_hi:[0,0]
  v_pk_mul_f32 v[56:57], s[46:47], 1.0 op_sel_hi:[0,0]
  v_pk_mul_f32 v[58:59], s[46:47], 1.0 op_sel_hi:[0,0]
  v_pk_mul_f32 v[60:61], s[46:47], 1.0 op_sel_hi:[0,0]
  v_pk_mul_f32 v[62:63], s[46:47], 1.0 op_sel_hi:[0,0]
  v_pk_mul_f32 v[64:65], s[46:47], 0 op_sel_hi:[0,0]
  v_pk_mul_f32 v[66:67], s[46:47], 0 op_sel_hi:[0,0]
  v_pk_mul_f32 v[68:69], s[46:47], 0 op_sel_hi:[0,0]
  v_pk_mul_f32 v[70:71], s[46:47], 0 op_sel_hi:[0,0]
  v_pk_mul_f32 v[72:73], s[46:47], 1.0 op_sel_hi:[0,0]
  v_pk_mul_f32 v[74:75], s[46:47], 1.0 op_sel_hi:[0,0]
  v_pk_mul_f32 v[76:77], s[46:47], 1.0 op_sel_hi:[0,0]
  v_pk_mul_f32 v[78:79], s[46:47], 1.0 op_sel_hi:[0,0]
  v_pk_mul_f32 v[80:81], s[46:47], 1.0 op_sel_hi:[0,0]
  v_pk_mul_f32 v[82:83], s[46:47], 1.0 op_sel_hi:[0,0]
  v_pk_mul_f32 v[84:85], s[46:47], 1.0 op_sel_hi:[0,0]
  v_pk_mul_f32 v[86:87], s[46:47], 1.0 op_sel_hi:[0,0]
  v_pk_mul_f32 v[88:89], s[46:47], 0 op_sel_hi:[0,0]
  v_pk_mul_f32 v[90:91], s[46:47], 0 op_sel_hi:[0,0]
  v_pk_mul_f32 v[92:93], s[46:47], 0 op_sel_hi:[0,0]
  v_pk_mul_f32 v[94:95], s[46:47], 0 op_sel_hi:[0,0]
  v_pk_mul_f32 v[96:97], s[46:47], 1.0 op_sel_hi:[0,0]
  v_pk_mul_f32 v[98:99], s[46:47], 1.0 op_sel_hi:[0,0]
  v_pk_mul_f32 v[100:101], s[46:47], 1.0 op_sel_hi:[0,0]
  v_pk_mul_f32 v[102:103], s[46:47], 1.0 op_sel_hi:[0,0]
  v_pk_mul_f32 v[104:105], s[46:47], 1.0 op_sel_hi:[0,0]
  v_pk_mul_f32 v[106:107], s[46:47], 1.0 op_sel_hi:[0,0]
  v_pk_mul_f32 v[108:109], s[46:47], 1.0 op_sel_hi:[0,0]
  v_pk_mul_f32 v[110:111], s[46:47], 1.0 op_sel_hi:[0,0]
  v_pk_mul_f32 v[112:113], s[46:47], 0 op_sel_hi:[0,0]
  v_pk_mul_f32 v[114:115], s[46:47], 0 op_sel_hi:[0,0]
  v_pk_mul_f32 v[116:117], s[46:47], 0 op_sel_hi:[0,0]
  v_pk_mul_f32 v[118:119], s[46:47], 0 op_sel_hi:[0,0]
  v_pk_mul_f32 v[120:121], s[46:47], 1.0 op_sel_hi:[0,0]
  v_pk_mul_f32 v[122:123], s[46:47], 1.0 op_sel_hi:[0,0]
  v_pk_mul_f32 v[124:125], s[46:47], 1.0 op_sel_hi:[0,0]
  v_pk_mul_f32 v[126:127], s[46:47], 1.0 op_sel_hi:[0,0]
  v_pk_mul_f32 v[128:129], s[46:47], 1.0 op_sel_hi:[0,0]
  v_pk_mul_f32 v[130:131], s[46:47], 1.0 op_sel_hi:[0,0]
  v_pk_mul_f32 v[132:133], s[46:47], 1.0 op_sel_hi:[0,0]
  v_pk_mul_f32 v[134:135], s[46:47], 1.0 op_sel_hi:[0,0]
  v_pk_mul_f32 v[136:137], s[46:47], 0 op_sel_hi:[0,0]
  v_pk_mul_f32 v[138:139], s[46:47], 0 op_sel_hi:[0,0]
  v_pk_mul_f32 v[140:141], s[46:47], 0 op_sel_hi:[0,0]
  v_pk_mul_f32 v[142:143], s[46:47], 0 op_sel_hi:[0,0]
  v_pk_mul_f32 v[144:145], s[46:47], 1.0 op_sel_hi:[0,0]
  v_pk_mul_f32 v[146:147], s[46:47], 1.0 op_sel_hi:[0,0]
  v_pk_mul_f32 v[148:149], s[46:47], 1.0 op_sel_hi:[0,0]
  v_pk_mul_f32 v[150:151], s[46:47], 1.0 op_sel_hi:[0,0]
  v_pk_mul_f32 v[152:153], s[46:47], 1.0 op_sel_hi:[0,0]
  v_pk_mul_f32 v[154:155], s[46:47], 1.0 op_sel_hi:[0,0]
  v_pk_mul_f32 v[156:157], s[46:47], 1.0 op_sel_hi:[0,0]
  v_pk_mul_f32 v[158:159], s[46:47], 1.0 op_sel_hi:[0,0]
  v_pk_mul_f32 v[160:161], s[46:47], 0 op_sel_hi:[0,0]
  v_pk_mul_f32 v[162:163], s[46:47], 0 op_sel_hi:[0,0]
  v_pk_mul_f32 v[164:165], s[46:47], 0 op_sel_hi:[0,0]
  v_pk_mul_f32 v[166:167], s[46:47], 0 op_sel_hi:[0,0]
  v_pk_mul_f32 v[168:169], s[46:47], 1.0 op_sel_hi:[0,0]
  v_pk_mul_f32 v[170:171], s[46:47], 1.0 op_sel_hi:[0,0]
  v_pk_mul_f32 v[172:173], s[46:47], 1.0 op_sel_hi:[0,0]
  v_pk_mul_f32 v[174:175], s[46:47], 1.0 op_sel_hi:[0,0]
  v_pk_mul_f32 v[176:177], s[46:47], 1.0 op_sel_hi:[0,0]
  v_pk_mul_f32 v[178:179], s[46:47], 1.0 op_sel_hi:[0,0]
  v_pk_mul_f32 v[180:181], s[46:47], 1.0 op_sel_hi:[0,0]
  v_pk_mul_f32 v[182:183], s[46:47], 1.0 op_sel_hi:[0,0]
  v_pk_mul_f32 v[184:185], s[46:47], 0 op_sel_hi:[0,0]
  v_pk_mul_f32 v[186:187], s[46:47], 0 op_sel_hi:[0,0]
  v_pk_mul_f32 v[188:189], s[46:47], 0 op_sel_hi:[0,0]
  v_pk_mul_f32 v[190:191], s[46:47], 0 op_sel_hi:[0,0]
  s_add_u32 m0, s54, 0
  s_add_u32 s48, 0, 0
  buffer_load_dwordx4 v10, s[24:27], s48 offen offset:0  lds
  buffer_load_dwordx4 v11, s[24:27], s48 offen offset:1024  lds
  buffer_load_dwordx4 v12, s[24:27], s48 offen offset:2048  lds
  buffer_load_dwordx4 v13, s[24:27], s48 offen offset:3072  lds
  s_add_u32 m0, s54, 4096
  s_add_u32 s48, 0, 65536
  buffer_load_dwordx4 v10, s[24:27], s48 offen offset:0  lds
  buffer_load_dwordx4 v11, s[24:27], s48 offen offset:1024  lds
  buffer_load_dwordx4 v12, s[24:27], s48 offen offset:2048  lds
  buffer_load_dwordx4 v13, s[24:27], s48 offen offset:3072  lds
  s_barrier
  v_and_b32 v1, 15, v0
  v_lshrrev_b32 v2, 4, v0
  v_bfe_u32 v3, v0, 1, 3
  v_xor_b32 v3, v2, v3
  v_lshlrev_b32 v3, 4, v3
  v_lshl_add_u32 v3, v1, 7, v3
  s_lshr_b32 s46, s40, 1
  s_lshl_b32 s46, s46, 13
  v_add_u32 v248, s46, v3
  v_xor_b32 v249, 64, v248
  v_bfe_u32 v3, v0, 2, 2
  v_lshl_add_u32 v4, v2, 3, v3
  v_lshlrev_b32 v4, 7, v4
  v_bfe_u32 v5, v0, 3, 2
  s_and_b32 s46, s40, 1
  s_lshl_b32 s46, s46, 1
  v_xor_b32 v5, s46, v5
  v_lshl_add_u32 v4, v5, 5, v4
  v_and_b32 v5, 3, v0
  v_lshl_add_u32 v4, v5, 3, v4
  v_add_u32 v250, 98304, v4
  v_xor_b32 v251, 32, v250
  s_mov_b32 s53, 32768
  s_mov_b32 s80, s8
  s_and_b32 s81, s9, 0xffff
  s_mov_b32 s82, 0x200000
  s_mov_b32 s83, 0x20000
  s_mov_b32 s84, s14
  s_and_b32 s85, s15, 0xffff
  s_mov_b32 s86, 0x200000
  s_mov_b32 s87, 0x20000

  s_lshl_b32 s49, s43, 4
  s_add_u32 s49, s49, s42
  s_lshl_b32 s49, s49, 3
  s_add_u32 s49, s49, s41
  s_lshl_b32 s49, s49, 11
  s_add_u32 s63, s49, 23068672
  s_and_b32 s79, s45, 7
  s_xor_b32 s79, s79, 1
  s_bfe_u32 s77, s45, 0x10003
  s_and_b32 s49, s44, 1
  s_lshl_b32 s49, s49, 3
  s_add_u32 s79, s79, s49
  s_lshr_b32 s75, s45, 1
  s_and_b32 s75, s75, 0
  s_lshl_b32 s75, s75, 19
  s_lshr_b32 s78, s45, 4
  s_and_b32 s49, s44, 6
  s_add_u32 s78, s78, s49
  s_add_u32 s32, s22, 0
  s_addc_u32 s33, s23, 0
  s_and_b32 s33, s33, 0xffff
  s_mov_b32 s34, 27262976
  s_mov_b32 s35, 0x20000
  s_mov_b32 s36, s20
  s_and_b32 s37, s21, 0xffff
  s_mov_b32 s38, 256
  s_mov_b32 s39, 0x20000

  s_cmp_eq_u32 s43, 0
  s_cselect_b32 s46, 1.0, 0
  .p2align 3
  v_pk_mul_f32 v[0:1], s[46:47], 1.0 op_sel_hi:[0,0]
  v_pk_mul_f32 v[2:3], s[46:47], 1.0 op_sel_hi:[0,0]
  v_pk_mul_f32 v[4:5], s[46:47], 1.0 op_sel_hi:[0,0]
  v_pk_mul_f32 v[6:7], s[46:47], 1.0 op_sel_hi:[0,0]
  v_pk_mul_f32 v[8:9], s[46:47], 1.0 op_sel_hi:[0,0]
  v_pk_mul_f32 v[10:11], s[46:47], 1.0 op_sel_hi:[0,0]
  v_pk_mul_f32 v[12:13], s[46:47], 1.0 op_sel_hi:[0,0]
  v_pk_mul_f32 v[14:15], s[46:47], 1.0 op_sel_hi:[0,0]
  v_pk_mul_f32 v[16:17], s[46:47], 0 op_sel_hi:[0,0]
  v_pk_mul_f32 v[18:19], s[46:47], 0 op_sel_hi:[0,0]
  v_pk_mul_f32 v[20:21], s[46:47], 0 op_sel_hi:[0,0]
  v_pk_mul_f32 v[22:23], s[46:47], 0 op_sel_hi:[0,0]
  v_mov_b32 v192, 147456
  v_mov_b32 v193, 1
  s_mov_b64 exec, 1
  s_waitcnt vmcnt(0)
  ds_add_u32 v192, v193
  s_mov_b64 exec, -1

L_st0:
  ds_read_b32 v194, v192
  s_waitcnt lgkmcnt(0)
  v_readfirstlane_b32 s46, v194
  s_cmp_lt_u32 s46, 4
  s_cbranch_scc1 L_st0

  s_cmp_eq_u32 s43, 0
  s_cbranch_scc1 L_consA
  s_mov_b32 s50, 8
  s_mov_b32 s51, 0
  ds_read_b128 v[192:195], v248 offset:16384
  ds_read_b128 v[196:199], v248 offset:18432
  ds_read_b64_tr_b16 v[224:225], v250 offset:0
  ds_read_b64_tr_b16 v[226:227], v250 offset:512
  ds_read_b128 v[200:203], v248 offset:20480
  ds_read_b128 v[204:207], v248 offset:22528
  ds_read_b64_tr_b16 v[228:229], v251 offset:0
  ds_read_b64_tr_b16 v[230:231], v251 offset:512
  ds_read_b64_tr_b16 v[232:233], v250 offset:8192
  ds_read_b64_tr_b16 v[234:235], v250 offset:8704
  ds_read_b64_tr_b16 v[236:237], v251 offset:8192
  ds_read_b64_tr_b16 v[238:239], v251 offset:8704
  ds_read_b64_tr_b16 v[240:241], v250 offset:16384
  ds_read_b64_tr_b16 v[242:243], v250 offset:16896
  s_branch L_gemm_eB
L_gemm_B:
  ds_read_b128 v[192:195], v248 offset:16384
  v_mfma_f32_16x16x32_bf16 v[144:147], v[224:227], v[216:219], v[144:147]
  ds_read_b128 v[196:199], v248 offset:18432
  v_mfma_f32_16x16x32_bf16 v[168:171], v[224:227], v[220:223], v[168:171]
  ds_read_b64_tr_b16 v[224:225], v250 offset:0
  v_mfma_f32_16x16x32_bf16 v[172:175], v[228:231], v[220:223], v[172:175]
  ds_read_b64_tr_b16 v[226:227], v250 offset:512
  v_mfma_f32_16x16x32_bf16 v[148:151], v[228:231], v[216:219], v[148:151]
  ds_read_b128 v[200:203], v248 offset:20480
  v_mfma_f32_16x16x32_bf16 v[124:127], v[228:231], v[212:215], v[124:127]
  ds_read_b128 v[204:207], v248 offset:22528
  v_mfma_f32_16x16x32_bf16 v[100:103], v[228:231], v[208:211], v[100:103]
  ds_read_b64_tr_b16 v[228:229], v251 offset:0
  v_mfma_f32_16x16x32_bf16 v[104:107], v[232:235], v[208:211], v[104:107]
  ds_read_b64_tr_b16 v[230:231], v251 offset:512
  v_mfma_f32_16x16x32_bf16 v[128:131], v[232:235], v[212:215], v[128:131]
  v_mfma_f32_16x16x32_bf16 v[152:155], v[232:235], v[216:219], v[152:155]
  v_mfma_f32_16x16x32_bf16 v[176:179], v[232:235], v[220:223], v[176:179]
  ds_read_b64_tr_b16 v[232:233], v250 offset:8192
  v_mfma_f32_16x16x32_bf16 v[180:183], v[236:239], v[220:223], v[180:183]
  ds_read_b64_tr_b16 v[234:235], v250 offset:8704
  v_mfma_f32_16x16x32_bf16 v[156:159], v[236:239], v[216:219], v[156:159]
  v_mfma_f32_16x16x32_bf16 v[132:135], v[236:239], v[212:215], v[132:135]
  v_mfma_f32_16x16x32_bf16 v[108:111], v[236:239], v[208:211], v[108:111]
  ds_read_b64_tr_b16 v[236:237], v251 offset:8192
  v_mfma_f32_16x16x32_bf16 v[112:115], v[208:211], v[240:243], v[112:115]
  ds_read_b64_tr_b16 v[238:239], v251 offset:8704
  v_mfma_f32_16x16x32_bf16 v[136:139], v[212:215], v[240:243], v[136:139]
  v_mfma_f32_16x16x32_bf16 v[160:163], v[216:219], v[240:243], v[160:163]
  v_mfma_f32_16x16x32_bf16 v[184:187], v[220:223], v[240:243], v[184:187]
  ds_read_b64_tr_b16 v[240:241], v250 offset:16384
  v_mfma_f32_16x16x32_bf16 v[188:191], v[220:223], v[244:247], v[188:191]
  ds_read_b64_tr_b16 v[242:243], v250 offset:16896
  v_mfma_f32_16x16x32_bf16 v[164:167], v[216:219], v[244:247], v[164:167]
  v_mfma_f32_16x16x32_bf16 v[140:143], v[212:215], v[244:247], v[140:143]
  v_mfma_f32_16x16x32_bf16 v[116:119], v[208:211], v[244:247], v[116:119]
L_gemm_eB:
  s_waitcnt lgkmcnt(10)
  v_mfma_f32_16x16x32_bf16 v[0:3], v[224:227], v[192:195], v[0:3]
  ds_read_b64_tr_b16 v[244:245], v251 offset:16384
  v_mfma_f32_16x16x32_bf16 v[24:27], v[224:227], v[196:199], v[24:27]
  ds_read_b64_tr_b16 v[246:247], v251 offset:16896
  s_waitcnt lgkmcnt(11)
  v_mfma_f32_16x16x32_bf16 v[48:51], v[224:227], v[200:203], v[48:51]
  ds_read_b128 v[208:211], v248 offset:0
  s_waitcnt lgkmcnt(11)
  v_mfma_f32_16x16x32_bf16 v[72:75], v[224:227], v[204:207], v[72:75]
  s_waitcnt lgkmcnt(9)
  v_mfma_f32_16x16x32_bf16 v[76:79], v[228:231], v[204:207], v[76:79]
  ds_read_b128 v[212:215], v248 offset:2048
  v_mfma_f32_16x16x32_bf16 v[52:55], v[228:231], v[200:203], v[52:55]
  v_mfma_f32_16x16x32_bf16 v[28:31], v[228:231], v[196:199], v[28:31]
  ds_read_b128 v[216:219], v248 offset:4096
  v_mfma_f32_16x16x32_bf16 v[4:7], v[228:231], v[192:195], v[4:7]
  s_waitcnt lgkmcnt(9)
  v_mfma_f32_16x16x32_bf16 v[8:11], v[232:235], v[192:195], v[8:11]
  ds_read_b128 v[220:223], v248 offset:6144
  v_mfma_f32_16x16x32_bf16 v[32:35], v[232:235], v[196:199], v[32:35]
  v_mfma_f32_16x16x32_bf16 v[56:59], v[232:235], v[200:203], v[56:59]
  s_add_u32 s51, s51, 1
  v_mfma_f32_16x16x32_bf16 v[80:83], v[232:235], v[204:207], v[80:83]
  s_cmp_eq_u32 s51, 3
  s_waitcnt lgkmcnt(8)
  v_mfma_f32_16x16x32_bf16 v[84:87], v[236:239], v[204:207], v[84:87]
  s_cselect_b32 s52, 4294901760, s53
  v_mfma_f32_16x16x32_bf16 v[60:63], v[236:239], v[200:203], v[60:63]
  s_cselect_b32 s51, 0, s51
  v_mfma_f32_16x16x32_bf16 v[36:39], v[236:239], v[196:199], v[36:39]
  v_mfma_f32_16x16x32_bf16 v[12:15], v[236:239], v[192:195], v[12:15]
  s_waitcnt lgkmcnt(6)
  v_mfma_f32_16x16x32_bf16 v[16:19], v[192:195], v[240:243], v[16:19]
  v_add_u32 v248, s52, v248
  v_mfma_f32_16x16x32_bf16 v[40:43], v[196:199], v[240:243], v[40:43]
  v_mfma_f32_16x16x32_bf16 v[64:67], v[200:203], v[240:243], v[64:67]
  v_mfma_f32_16x16x32_bf16 v[88:91], v[204:207], v[240:243], v[88:91]
  s_waitcnt lgkmcnt(4)
  v_mfma_f32_16x16x32_bf16 v[92:95], v[204:207], v[244:247], v[92:95]
  v_mfma_f32_16x16x32_bf16 v[68:71], v[200:203], v[244:247], v[68:71]
  v_mfma_f32_16x16x32_bf16 v[44:47], v[196:199], v[244:247], v[44:47]
  v_mfma_f32_16x16x32_bf16 v[20:23], v[192:195], v[244:247], v[20:23]
  s_waitcnt lgkmcnt(3)
  v_mfma_f32_16x16x32_bf16 v[96:99], v[224:227], v[208:211], v[96:99]
  ds_read_b128 v[192:195], v249 offset:16384
  s_waitcnt lgkmcnt(3)
  v_mfma_f32_16x16x32_bf16 v[120:123], v[224:227], v[212:215], v[120:123]
  ds_read_b128 v[196:199], v249 offset:18432
  s_waitcnt lgkmcnt(3)
  v_mfma_f32_16x16x32_bf16 v[144:147], v[224:227], v[216:219], v[144:147]
  s_waitcnt lgkmcnt(2)
  v_mfma_f32_16x16x32_bf16 v[168:171], v[224:227], v[220:223], v[168:171]
  ds_read_b64_tr_b16 v[224:225], v250 offset:4096
  v_mfma_f32_16x16x32_bf16 v[172:175], v[228:231], v[220:223], v[172:175]
  ds_read_b64_tr_b16 v[226:227], v250 offset:4608
  v_mfma_f32_16x16x32_bf16 v[148:151], v[228:231], v[216:219], v[148:151]
  ds_read_b128 v[200:203], v249 offset:20480
  v_mfma_f32_16x16x32_bf16 v[124:127], v[228:231], v[212:215], v[124:127]
  ds_read_b128 v[204:207], v249 offset:22528
  v_mfma_f32_16x16x32_bf16 v[100:103], v[228:231], v[208:211], v[100:103]
  ds_read_b64_tr_b16 v[228:229], v251 offset:4096
  v_mfma_f32_16x16x32_bf16 v[104:107], v[232:235], v[208:211], v[104:107]
  ds_read_b64_tr_b16 v[230:231], v251 offset:4608
  v_mfma_f32_16x16x32_bf16 v[128:131], v[232:235], v[212:215], v[128:131]
  v_mfma_f32_16x16x32_bf16 v[152:155], v[232:235], v[216:219], v[152:155]
  v_mfma_f32_16x16x32_bf16 v[176:179], v[232:235], v[220:223], v[176:179]
  ds_read_b64_tr_b16 v[232:233], v250 offset:12288
  v_mfma_f32_16x16x32_bf16 v[180:183], v[236:239], v[220:223], v[180:183]
  ds_read_b64_tr_b16 v[234:235], v250 offset:12800
  v_mfma_f32_16x16x32_bf16 v[156:159], v[236:239], v[216:219], v[156:159]
  v_mfma_f32_16x16x32_bf16 v[132:135], v[236:239], v[212:215], v[132:135]
  v_mfma_f32_16x16x32_bf16 v[108:111], v[236:239], v[208:211], v[108:111]
  ds_read_b64_tr_b16 v[236:237], v251 offset:12288
  v_mfma_f32_16x16x32_bf16 v[112:115], v[208:211], v[240:243], v[112:115]
  ds_read_b64_tr_b16 v[238:239], v251 offset:12800
  v_mfma_f32_16x16x32_bf16 v[136:139], v[212:215], v[240:243], v[136:139]
  v_mfma_f32_16x16x32_bf16 v[160:163], v[216:219], v[240:243], v[160:163]
  v_mfma_f32_16x16x32_bf16 v[184:187], v[220:223], v[240:243], v[184:187]
  ds_read_b64_tr_b16 v[240:241], v250 offset:20480
  v_mfma_f32_16x16x32_bf16 v[188:191], v[220:223], v[244:247], v[188:191]
  ds_read_b64_tr_b16 v[242:243], v250 offset:20992
  v_mfma_f32_16x16x32_bf16 v[164:167], v[216:219], v[244:247], v[164:167]
  v_mfma_f32_16x16x32_bf16 v[140:143], v[212:215], v[244:247], v[140:143]
  v_mfma_f32_16x16x32_bf16 v[116:119], v[208:211], v[244:247], v[116:119]
  s_waitcnt lgkmcnt(10)
  v_mfma_f32_16x16x32_bf16 v[0:3], v[224:227], v[192:195], v[0:3]
  ds_read_b64_tr_b16 v[244:245], v251 offset:20480
  v_mfma_f32_16x16x32_bf16 v[24:27], v[224:227], v[196:199], v[24:27]
  ds_read_b64_tr_b16 v[246:247], v251 offset:20992
  s_waitcnt lgkmcnt(11)
  v_mfma_f32_16x16x32_bf16 v[48:51], v[224:227], v[200:203], v[48:51]
  ds_read_b128 v[208:211], v249 offset:0
  s_waitcnt lgkmcnt(11)
  v_mfma_f32_16x16x32_bf16 v[72:75], v[224:227], v[204:207], v[72:75]
  s_waitcnt lgkmcnt(9)
  v_mfma_f32_16x16x32_bf16 v[76:79], v[228:231], v[204:207], v[76:79]
  ds_read_b128 v[212:215], v249 offset:2048
  v_mfma_f32_16x16x32_bf16 v[52:55], v[228:231], v[200:203], v[52:55]
  v_mfma_f32_16x16x32_bf16 v[28:31], v[228:231], v[196:199], v[28:31]
  ds_read_b128 v[216:219], v249 offset:4096
  v_mfma_f32_16x16x32_bf16 v[4:7], v[228:231], v[192:195], v[4:7]
  s_waitcnt lgkmcnt(9)
  v_mfma_f32_16x16x32_bf16 v[8:11], v[232:235], v[192:195], v[8:11]
  ds_read_b128 v[220:223], v249 offset:6144
  v_mfma_f32_16x16x32_bf16 v[32:35], v[232:235], v[196:199], v[32:35]
  v_mfma_f32_16x16x32_bf16 v[56:59], v[232:235], v[200:203], v[56:59]
  v_mfma_f32_16x16x32_bf16 v[80:83], v[232:235], v[204:207], v[80:83]
  s_waitcnt lgkmcnt(8)
  v_mfma_f32_16x16x32_bf16 v[84:87], v[236:239], v[204:207], v[84:87]
  v_mfma_f32_16x16x32_bf16 v[60:63], v[236:239], v[200:203], v[60:63]
  v_mfma_f32_16x16x32_bf16 v[36:39], v[236:239], v[196:199], v[36:39]
  v_mfma_f32_16x16x32_bf16 v[12:15], v[236:239], v[192:195], v[12:15]
  s_waitcnt lgkmcnt(6)
  v_mfma_f32_16x16x32_bf16 v[16:19], v[192:195], v[240:243], v[16:19]
  v_add_u32 v249, s52, v249
  v_mfma_f32_16x16x32_bf16 v[40:43], v[196:199], v[240:243], v[40:43]
  v_mfma_f32_16x16x32_bf16 v[64:67], v[200:203], v[240:243], v[64:67]
  v_mfma_f32_16x16x32_bf16 v[88:91], v[204:207], v[240:243], v[88:91]
  s_waitcnt lgkmcnt(4)
  v_mfma_f32_16x16x32_bf16 v[92:95], v[204:207], v[244:247], v[92:95]
  v_mfma_f32_16x16x32_bf16 v[68:71], v[200:203], v[244:247], v[68:71]
  v_mfma_f32_16x16x32_bf16 v[44:47], v[196:199], v[244:247], v[44:47]
  v_mfma_f32_16x16x32_bf16 v[20:23], v[192:195], v[244:247], v[20:23]
  s_waitcnt lgkmcnt(3)
  v_mfma_f32_16x16x32_bf16 v[96:99], v[224:227], v[208:211], v[96:99]
  s_waitcnt lgkmcnt(0)
  s_barrier
  v_mfma_f32_16x16x32_bf16 v[120:123], v[224:227], v[212:215], v[120:123]
  ds_read_b128 v[192:195], v248 offset:16384
  v_mfma_f32_16x16x32_bf16 v[144:147], v[224:227], v[216:219], v[144:147]
  ds_read_b128 v[196:199], v248 offset:18432
  v_mfma_f32_16x16x32_bf16 v[168:171], v[224:227], v[220:223], v[168:171]
  ds_read_b64_tr_b16 v[224:225], v250 offset:24576
  v_mfma_f32_16x16x32_bf16 v[172:175], v[228:231], v[220:223], v[172:175]
  ds_read_b64_tr_b16 v[226:227], v250 offset:25088
  v_mfma_f32_16x16x32_bf16 v[148:151], v[228:231], v[216:219], v[148:151]
  ds_read_b128 v[200:203], v248 offset:20480
  v_mfma_f32_16x16x32_bf16 v[124:127], v[228:231], v[212:215], v[124:127]
  ds_read_b128 v[204:207], v248 offset:22528
  v_mfma_f32_16x16x32_bf16 v[100:103], v[228:231], v[208:211], v[100:103]
  ds_read_b64_tr_b16 v[228:229], v251 offset:24576
  v_mfma_f32_16x16x32_bf16 v[104:107], v[232:235], v[208:211], v[104:107]
  ds_read_b64_tr_b16 v[230:231], v251 offset:25088
  v_mfma_f32_16x16x32_bf16 v[128:131], v[232:235], v[212:215], v[128:131]
  v_mfma_f32_16x16x32_bf16 v[152:155], v[232:235], v[216:219], v[152:155]
  v_mfma_f32_16x16x32_bf16 v[176:179], v[232:235], v[220:223], v[176:179]
  ds_read_b64_tr_b16 v[232:233], v250 offset:32768
  v_mfma_f32_16x16x32_bf16 v[180:183], v[236:239], v[220:223], v[180:183]
  ds_read_b64_tr_b16 v[234:235], v250 offset:33280
  v_mfma_f32_16x16x32_bf16 v[156:159], v[236:239], v[216:219], v[156:159]
  v_mfma_f32_16x16x32_bf16 v[132:135], v[236:239], v[212:215], v[132:135]
  v_mfma_f32_16x16x32_bf16 v[108:111], v[236:239], v[208:211], v[108:111]
  ds_read_b64_tr_b16 v[236:237], v251 offset:32768
  v_mfma_f32_16x16x32_bf16 v[112:115], v[208:211], v[240:243], v[112:115]
  ds_read_b64_tr_b16 v[238:239], v251 offset:33280
  v_mfma_f32_16x16x32_bf16 v[136:139], v[212:215], v[240:243], v[136:139]
  v_mfma_f32_16x16x32_bf16 v[160:163], v[216:219], v[240:243], v[160:163]
  v_mfma_f32_16x16x32_bf16 v[184:187], v[220:223], v[240:243], v[184:187]
  ds_read_b64_tr_b16 v[240:241], v250 offset:40960
  v_mfma_f32_16x16x32_bf16 v[188:191], v[220:223], v[244:247], v[188:191]
  ds_read_b64_tr_b16 v[242:243], v250 offset:41472
  v_mfma_f32_16x16x32_bf16 v[164:167], v[216:219], v[244:247], v[164:167]
  v_mfma_f32_16x16x32_bf16 v[140:143], v[212:215], v[244:247], v[140:143]
  v_mfma_f32_16x16x32_bf16 v[116:119], v[208:211], v[244:247], v[116:119]
  s_waitcnt lgkmcnt(10)
  v_mfma_f32_16x16x32_bf16 v[0:3], v[224:227], v[192:195], v[0:3]
  ds_read_b64_tr_b16 v[244:245], v251 offset:40960
  v_mfma_f32_16x16x32_bf16 v[24:27], v[224:227], v[196:199], v[24:27]
  ds_read_b64_tr_b16 v[246:247], v251 offset:41472
  s_waitcnt lgkmcnt(11)
  v_mfma_f32_16x16x32_bf16 v[48:51], v[224:227], v[200:203], v[48:51]
  ds_read_b128 v[208:211], v248 offset:0
  s_waitcnt lgkmcnt(11)
  v_mfma_f32_16x16x32_bf16 v[72:75], v[224:227], v[204:207], v[72:75]
  s_waitcnt lgkmcnt(9)
  v_mfma_f32_16x16x32_bf16 v[76:79], v[228:231], v[204:207], v[76:79]
  ds_read_b128 v[212:215], v248 offset:2048
  v_mfma_f32_16x16x32_bf16 v[52:55], v[228:231], v[200:203], v[52:55]
  v_mfma_f32_16x16x32_bf16 v[28:31], v[228:231], v[196:199], v[28:31]
  ds_read_b128 v[216:219], v248 offset:4096
  v_mfma_f32_16x16x32_bf16 v[4:7], v[228:231], v[192:195], v[4:7]
  s_waitcnt lgkmcnt(9)
  v_mfma_f32_16x16x32_bf16 v[8:11], v[232:235], v[192:195], v[8:11]
  ds_read_b128 v[220:223], v248 offset:6144
  v_mfma_f32_16x16x32_bf16 v[32:35], v[232:235], v[196:199], v[32:35]
  v_mfma_f32_16x16x32_bf16 v[56:59], v[232:235], v[200:203], v[56:59]
  s_add_u32 s51, s51, 1
  v_mfma_f32_16x16x32_bf16 v[80:83], v[232:235], v[204:207], v[80:83]
  s_cmp_eq_u32 s51, 3
  s_waitcnt lgkmcnt(8)
  v_mfma_f32_16x16x32_bf16 v[84:87], v[236:239], v[204:207], v[84:87]
  s_cselect_b32 s52, 4294901760, s53
  v_mfma_f32_16x16x32_bf16 v[60:63], v[236:239], v[200:203], v[60:63]
  s_cselect_b32 s51, 0, s51
  v_mfma_f32_16x16x32_bf16 v[36:39], v[236:239], v[196:199], v[36:39]
  v_mfma_f32_16x16x32_bf16 v[12:15], v[236:239], v[192:195], v[12:15]
  s_waitcnt lgkmcnt(6)
  v_mfma_f32_16x16x32_bf16 v[16:19], v[192:195], v[240:243], v[16:19]
  v_add_u32 v248, s52, v248
  v_mfma_f32_16x16x32_bf16 v[40:43], v[196:199], v[240:243], v[40:43]
  v_mfma_f32_16x16x32_bf16 v[64:67], v[200:203], v[240:243], v[64:67]
  v_mfma_f32_16x16x32_bf16 v[88:91], v[204:207], v[240:243], v[88:91]
  s_waitcnt lgkmcnt(4)
  v_mfma_f32_16x16x32_bf16 v[92:95], v[204:207], v[244:247], v[92:95]
  v_mfma_f32_16x16x32_bf16 v[68:71], v[200:203], v[244:247], v[68:71]
  v_mfma_f32_16x16x32_bf16 v[44:47], v[196:199], v[244:247], v[44:47]
  v_mfma_f32_16x16x32_bf16 v[20:23], v[192:195], v[244:247], v[20:23]
  s_waitcnt lgkmcnt(3)
  v_mfma_f32_16x16x32_bf16 v[96:99], v[224:227], v[208:211], v[96:99]
  ds_read_b128 v[192:195], v249 offset:16384
  s_waitcnt lgkmcnt(3)
  v_mfma_f32_16x16x32_bf16 v[120:123], v[224:227], v[212:215], v[120:123]
  ds_read_b128 v[196:199], v249 offset:18432
  s_waitcnt lgkmcnt(3)
  v_mfma_f32_16x16x32_bf16 v[144:147], v[224:227], v[216:219], v[144:147]
  s_waitcnt lgkmcnt(2)
  v_mfma_f32_16x16x32_bf16 v[168:171], v[224:227], v[220:223], v[168:171]
  ds_read_b64_tr_b16 v[224:225], v250 offset:28672
  v_mfma_f32_16x16x32_bf16 v[172:175], v[228:231], v[220:223], v[172:175]
  ds_read_b64_tr_b16 v[226:227], v250 offset:29184
  v_mfma_f32_16x16x32_bf16 v[148:151], v[228:231], v[216:219], v[148:151]
  ds_read_b128 v[200:203], v249 offset:20480
  v_mfma_f32_16x16x32_bf16 v[124:127], v[228:231], v[212:215], v[124:127]
  ds_read_b128 v[204:207], v249 offset:22528
  v_mfma_f32_16x16x32_bf16 v[100:103], v[228:231], v[208:211], v[100:103]
  ds_read_b64_tr_b16 v[228:229], v251 offset:28672
  v_mfma_f32_16x16x32_bf16 v[104:107], v[232:235], v[208:211], v[104:107]
  ds_read_b64_tr_b16 v[230:231], v251 offset:29184
  v_mfma_f32_16x16x32_bf16 v[128:131], v[232:235], v[212:215], v[128:131]
  v_mfma_f32_16x16x32_bf16 v[152:155], v[232:235], v[216:219], v[152:155]
  v_mfma_f32_16x16x32_bf16 v[176:179], v[232:235], v[220:223], v[176:179]
  ds_read_b64_tr_b16 v[232:233], v250 offset:36864
  v_mfma_f32_16x16x32_bf16 v[180:183], v[236:239], v[220:223], v[180:183]
  ds_read_b64_tr_b16 v[234:235], v250 offset:37376
  v_mfma_f32_16x16x32_bf16 v[156:159], v[236:239], v[216:219], v[156:159]
  v_mfma_f32_16x16x32_bf16 v[132:135], v[236:239], v[212:215], v[132:135]
  v_mfma_f32_16x16x32_bf16 v[108:111], v[236:239], v[208:211], v[108:111]
  ds_read_b64_tr_b16 v[236:237], v251 offset:36864
  v_mfma_f32_16x16x32_bf16 v[112:115], v[208:211], v[240:243], v[112:115]
  ds_read_b64_tr_b16 v[238:239], v251 offset:37376
  v_mfma_f32_16x16x32_bf16 v[136:139], v[212:215], v[240:243], v[136:139]
  v_mfma_f32_16x16x32_bf16 v[160:163], v[216:219], v[240:243], v[160:163]
  v_mfma_f32_16x16x32_bf16 v[184:187], v[220:223], v[240:243], v[184:187]
  ds_read_b64_tr_b16 v[240:241], v250 offset:45056
  v_mfma_f32_16x16x32_bf16 v[188:191], v[220:223], v[244:247], v[188:191]
  ds_read_b64_tr_b16 v[242:243], v250 offset:45568
  v_mfma_f32_16x16x32_bf16 v[164:167], v[216:219], v[244:247], v[164:167]
  v_mfma_f32_16x16x32_bf16 v[140:143], v[212:215], v[244:247], v[140:143]
  v_mfma_f32_16x16x32_bf16 v[116:119], v[208:211], v[244:247], v[116:119]
  s_waitcnt lgkmcnt(10)
  v_mfma_f32_16x16x32_bf16 v[0:3], v[224:227], v[192:195], v[0:3]
  ds_read_b64_tr_b16 v[244:245], v251 offset:45056
  v_mfma_f32_16x16x32_bf16 v[24:27], v[224:227], v[196:199], v[24:27]
  ds_read_b64_tr_b16 v[246:247], v251 offset:45568
  s_waitcnt lgkmcnt(11)
  v_mfma_f32_16x16x32_bf16 v[48:51], v[224:227], v[200:203], v[48:51]
  ds_read_b128 v[208:211], v249 offset:0
  s_waitcnt lgkmcnt(11)
  v_mfma_f32_16x16x32_bf16 v[72:75], v[224:227], v[204:207], v[72:75]
  s_waitcnt lgkmcnt(9)
  v_mfma_f32_16x16x32_bf16 v[76:79], v[228:231], v[204:207], v[76:79]
  ds_read_b128 v[212:215], v249 offset:2048
  v_mfma_f32_16x16x32_bf16 v[52:55], v[228:231], v[200:203], v[52:55]
  v_mfma_f32_16x16x32_bf16 v[28:31], v[228:231], v[196:199], v[28:31]
  ds_read_b128 v[216:219], v249 offset:4096
  v_mfma_f32_16x16x32_bf16 v[4:7], v[228:231], v[192:195], v[4:7]
  s_waitcnt lgkmcnt(9)
  v_mfma_f32_16x16x32_bf16 v[8:11], v[232:235], v[192:195], v[8:11]
  ds_read_b128 v[220:223], v249 offset:6144
  v_mfma_f32_16x16x32_bf16 v[32:35], v[232:235], v[196:199], v[32:35]
  v_mfma_f32_16x16x32_bf16 v[56:59], v[232:235], v[200:203], v[56:59]
  v_mfma_f32_16x16x32_bf16 v[80:83], v[232:235], v[204:207], v[80:83]
  s_waitcnt lgkmcnt(8)
  v_mfma_f32_16x16x32_bf16 v[84:87], v[236:239], v[204:207], v[84:87]
  v_mfma_f32_16x16x32_bf16 v[60:63], v[236:239], v[200:203], v[60:63]
  v_mfma_f32_16x16x32_bf16 v[36:39], v[236:239], v[196:199], v[36:39]
  v_mfma_f32_16x16x32_bf16 v[12:15], v[236:239], v[192:195], v[12:15]
  s_waitcnt lgkmcnt(6)
  v_mfma_f32_16x16x32_bf16 v[16:19], v[192:195], v[240:243], v[16:19]
  v_add_u32 v249, s52, v249
  v_mfma_f32_16x16x32_bf16 v[40:43], v[196:199], v[240:243], v[40:43]
  v_mfma_f32_16x16x32_bf16 v[64:67], v[200:203], v[240:243], v[64:67]
  s_sub_u32 s50, s50, 1
  v_mfma_f32_16x16x32_bf16 v[88:91], v[204:207], v[240:243], v[88:91]
  s_waitcnt lgkmcnt(4)
  v_mfma_f32_16x16x32_bf16 v[92:95], v[204:207], v[244:247], v[92:95]
  v_mfma_f32_16x16x32_bf16 v[68:71], v[200:203], v[244:247], v[68:71]
  s_cmp_lg_u32 s50, 0
  v_mfma_f32_16x16x32_bf16 v[44:47], v[196:199], v[244:247], v[44:47]
  v_mfma_f32_16x16x32_bf16 v[20:23], v[192:195], v[244:247], v[20:23]
  s_waitcnt lgkmcnt(3)
  v_mfma_f32_16x16x32_bf16 v[96:99], v[224:227], v[208:211], v[96:99]
  s_waitcnt lgkmcnt(0)
  s_barrier
  v_mfma_f32_16x16x32_bf16 v[120:123], v[224:227], v[212:215], v[120:123]
  s_cbranch_scc1 L_gemm_B
  v_mfma_f32_16x16x32_bf16 v[104:107], v[232:235], v[208:211], v[104:107]
  s_lshr_b32 s46, s40, 1
  s_and_b32 s47, s40, 1
  s_lshl_b32 s48, s47, 15
  s_lshl_b32 s49, s46, 12
  v_mfma_f32_16x16x32_bf16 v[128:131], v[232:235], v[212:215], v[128:131]
  s_add_u32 s48, s48, s49
  s_add_u32 s48, s48, 65536
  v_lshlrev_b32 v253, 4, v252
  v_add_u32 v248, s48, v253
  v_mfma_f32_16x16x32_bf16 v[152:155], v[232:235], v[216:219], v[152:155]
  s_lshl_b32 s48, s47, 14
  s_add_u32 s48, s48, s49
  s_add_u32 s48, s48, 131072
  v_add_u32 v249, s48, v253
  v_mfma_f32_16x16x32_bf16 v[176:179], v[232:235], v[220:223], v[176:179]
  s_lshl_b32 s48, s42, 3
  s_add_u32 s48, s48, s41
  s_mul_i32 s48, s48, 66816
  s_lshl_b32 s47, s47, 15
  v_mfma_f32_16x16x32_bf16 v[180:183], v[236:239], v[220:223], v[180:183]
  s_add_u32 s48, s48, s47
  s_add_u32 s48, s48, s49
  s_add_u32 s48, s48, 10485760
  s_cmp_eq_u32 s41, 99
  v_mfma_f32_16x16x32_bf16 v[156:159], v[236:239], v[216:219], v[156:159]
  s_cselect_b32 s48, 0x10000000, s48
  s_mov_b32 s49, s48
  s_add_u32 s48, s49, 8192
  s_add_u32 s50, s49, 24576
  v_mfma_f32_16x16x32_bf16 v[132:135], v[236:239], v[212:215], v[132:135]
  s_add_u32 s51, s49, 16384
  s_mov_b32 s64, 0x3e8293ee
  .p2align 3
  v_cvt_pk_bf16_f32 v8, v8, v9
  v_mfma_f32_16x16x32_bf16 v[108:111], v[236:239], v[208:211], v[108:111]
  v_cvt_pk_bf16_f32 v9, v10, v11
  v_cvt_pk_bf16_f32 v10, v12, v13
  v_cvt_pk_bf16_f32 v11, v14, v15
  buffer_store_dwordx4 v[8:11], v253, s[32:35], s48 offen offset:0 sc1
  v_mfma_f32_16x16x32_bf16 v[112:115], v[208:211], v[240:243], v[112:115]
  ds_write_b128 v248, v[8:11] offset:8192
  v_cvt_pk_bf16_f32 v32, v32, v33
  v_cvt_pk_bf16_f32 v33, v34, v35
  v_cvt_pk_bf16_f32 v34, v36, v37
  v_mfma_f32_16x16x32_bf16 v[136:139], v[212:215], v[240:243], v[136:139]
  v_cvt_pk_bf16_f32 v35, v38, v39
  buffer_store_dwordx4 v[32:35], v253, s[32:35], s48 offen offset:1024 sc1
  ds_write_b128 v248, v[32:35] offset:9216
  v_cvt_pk_bf16_f32 v16, v16, v17
  v_mfma_f32_16x16x32_bf16 v[160:163], v[216:219], v[240:243], v[160:163]
  v_cvt_pk_bf16_f32 v17, v18, v19
  v_cvt_pk_bf16_f32 v18, v40, v41
  v_cvt_pk_bf16_f32 v19, v42, v43
  buffer_store_dwordx4 v[16:19], v253, s[32:35], s50 offen offset:0 sc1
  v_mfma_f32_16x16x32_bf16 v[184:187], v[220:223], v[240:243], v[184:187]
  ds_write_b128 v248, v[16:19] offset:24576
  v_cvt_pk_bf16_f32 v20, v20, v21
  v_cvt_pk_bf16_f32 v21, v22, v23
  v_cvt_pk_bf16_f32 v22, v44, v45
  v_mfma_f32_16x16x32_bf16 v[188:191], v[220:223], v[244:247], v[188:191]
  v_cvt_pk_bf16_f32 v23, v46, v47
  buffer_store_dwordx4 v[20:23], v253, s[32:35], s50 offen offset:1024 sc1
  ds_write_b128 v248, v[20:23] offset:25600
  v_cvt_pk_bf16_f32 v56, v56, v57
  v_mfma_f32_16x16x32_bf16 v[164:167], v[216:219], v[244:247], v[164:167]
  v_cvt_pk_bf16_f32 v57, v58, v59
  v_cvt_pk_bf16_f32 v58, v60, v61
  v_cvt_pk_bf16_f32 v59, v62, v63
  buffer_store_dwordx4 v[56:59], v253, s[32:35], s48 offen offset:2048 sc1
  v_mfma_f32_16x16x32_bf16 v[140:143], v[212:215], v[244:247], v[140:143]
  ds_write_b128 v248, v[56:59] offset:10240
  v_cvt_pk_bf16_f32 v80, v80, v81
  v_cvt_pk_bf16_f32 v81, v82, v83
  v_cvt_pk_bf16_f32 v82, v84, v85
  v_mfma_f32_16x16x32_bf16 v[116:119], v[208:211], v[244:247], v[116:119]
  v_cvt_pk_bf16_f32 v83, v86, v87
  buffer_store_dwordx4 v[80:83], v253, s[32:35], s48 offen offset:3072 sc1
  ds_write_b128 v248, v[80:83] offset:11264
  v_cvt_pk_bf16_f32 v64, v64, v65
  v_mfma_f32_16x16x32_bf16 v[144:147], v[224:227], v[216:219], v[144:147]
  v_cvt_pk_bf16_f32 v65, v66, v67
  v_cvt_pk_bf16_f32 v66, v88, v89
  v_cvt_pk_bf16_f32 v67, v90, v91
  buffer_store_dwordx4 v[64:67], v253, s[32:35], s50 offen offset:2048 sc1
  v_mfma_f32_16x16x32_bf16 v[168:171], v[224:227], v[220:223], v[168:171]
  ds_write_b128 v248, v[64:67] offset:26624
  v_cvt_pk_bf16_f32 v68, v68, v69
  v_cvt_pk_bf16_f32 v69, v70, v71
  v_cvt_pk_bf16_f32 v70, v92, v93
  v_mfma_f32_16x16x32_bf16 v[172:175], v[228:231], v[220:223], v[172:175]
  v_cvt_pk_bf16_f32 v71, v94, v95
  buffer_store_dwordx4 v[68:71], v253, s[32:35], s50 offen offset:3072 sc1
  ds_write_b128 v248, v[68:71] offset:27648
  v_mfma_f32_16x16x32_bf16 v[148:151], v[228:231], v[216:219], v[148:151]
  v_mfma_f32_16x16x32_bf16 v[124:127], v[228:231], v[212:215], v[124:127]
  v_mfma_f32_16x16x32_bf16 v[100:103], v[228:231], v[208:211], v[100:103]
  .p2align 3
  v_cvt_pk_bf16_f32 v104, v104, v105
  v_cvt_pk_bf16_f32 v105, v106, v107
  v_cvt_pk_bf16_f32 v106, v108, v109
  v_cvt_pk_bf16_f32 v107, v110, v111
  buffer_store_dwordx4 v[104:107], v253, s[32:35], s49 offen offset:0 sc1
  ds_write_b128 v248, v[104:107] offset:0
  v_pk_mul_f32 v[0:1], v[0:1], s[64:65] op_sel_hi:[1,0]
  v_pk_mul_f32 v[2:3], v[2:3], s[64:65] op_sel_hi:[1,0]
  v_pk_mul_f32 v[4:5], v[4:5], s[64:65] op_sel_hi:[1,0]
  v_pk_mul_f32 v[6:7], v[6:7], s[64:65] op_sel_hi:[1,0]
  v_cvt_pk_bf16_f32 v0, v0, v1
  v_cvt_pk_bf16_f32 v1, v2, v3
  v_cvt_pk_bf16_f32 v2, v4, v5
  v_cvt_pk_bf16_f32 v3, v6, v7
  ds_write_b128 v249, v[0:3] offset:8192
  v_cvt_pk_bf16_f32 v128, v128, v129
  v_cvt_pk_bf16_f32 v129, v130, v131
  v_cvt_pk_bf16_f32 v130, v132, v133
  v_cvt_pk_bf16_f32 v131, v134, v135
  buffer_store_dwordx4 v[128:131], v253, s[32:35], s49 offen offset:1024 sc1
  ds_write_b128 v248, v[128:131] offset:1024
  v_pk_mul_f32 v[24:25], v[24:25], s[64:65] op_sel_hi:[1,0]
  v_pk_mul_f32 v[26:27], v[26:27], s[64:65] op_sel_hi:[1,0]
  v_pk_mul_f32 v[28:29], v[28:29], s[64:65] op_sel_hi:[1,0]
  v_pk_mul_f32 v[30:31], v[30:31], s[64:65] op_sel_hi:[1,0]
  v_cvt_pk_bf16_f32 v24, v24, v25
  v_cvt_pk_bf16_f32 v25, v26, v27
  v_cvt_pk_bf16_f32 v26, v28, v29
  v_cvt_pk_bf16_f32 v27, v30, v31
  ds_write_b128 v249, v[24:27] offset:9216
  v_cvt_pk_bf16_f32 v112, v112, v113
  v_cvt_pk_bf16_f32 v113, v114, v115
  v_cvt_pk_bf16_f32 v114, v136, v137
  v_cvt_pk_bf16_f32 v115, v138, v139
  buffer_store_dwordx4 v[112:115], v253, s[32:35], s51 offen offset:0 sc1
  ds_write_b128 v248, v[112:115] offset:16384
  v_cvt_pk_bf16_f32 v116, v116, v117
  v_cvt_pk_bf16_f32 v117, v118, v119
  v_cvt_pk_bf16_f32 v118, v140, v141
  v_cvt_pk_bf16_f32 v119, v142, v143
  buffer_store_dwordx4 v[116:119], v253, s[32:35], s51 offen offset:1024 sc1
  ds_write_b128 v248, v[116:119] offset:17408
  v_cvt_pk_bf16_f32 v152, v152, v153
  v_cvt_pk_bf16_f32 v153, v154, v155
  v_cvt_pk_bf16_f32 v154, v156, v157
  v_cvt_pk_bf16_f32 v155, v158, v159
  ds_write_b128 v248, v[152:155] offset:2048
  v_pk_mul_f32 v[48:49], v[48:49], s[64:65] op_sel_hi:[1,0]
  v_pk_mul_f32 v[50:51], v[50:51], s[64:65] op_sel_hi:[1,0]
  v_pk_mul_f32 v[52:53], v[52:53], s[64:65] op_sel_hi:[1,0]
  v_pk_mul_f32 v[54:55], v[54:55], s[64:65] op_sel_hi:[1,0]
  v_cvt_pk_bf16_f32 v48, v48, v49
  v_cvt_pk_bf16_f32 v49, v50, v51
  v_cvt_pk_bf16_f32 v50, v52, v53
  v_cvt_pk_bf16_f32 v51, v54, v55
  ds_write_b128 v249, v[48:51] offset:10240
  v_cvt_pk_bf16_f32 v176, v176, v177
  v_cvt_pk_bf16_f32 v177, v178, v179
  v_cvt_pk_bf16_f32 v178, v180, v181
  v_cvt_pk_bf16_f32 v179, v182, v183
  ds_write_b128 v248, v[176:179] offset:3072
  v_pk_mul_f32 v[72:73], v[72:73], s[64:65] op_sel_hi:[1,0]
  v_pk_mul_f32 v[74:75], v[74:75], s[64:65] op_sel_hi:[1,0]
  v_pk_mul_f32 v[76:77], v[76:77], s[64:65] op_sel_hi:[1,0]
  v_pk_mul_f32 v[78:79], v[78:79], s[64:65] op_sel_hi:[1,0]
  v_cvt_pk_bf16_f32 v72, v72, v73
  v_cvt_pk_bf16_f32 v73, v74, v75
  v_cvt_pk_bf16_f32 v74, v76, v77
  v_cvt_pk_bf16_f32 v75, v78, v79
  ds_write_b128 v249, v[72:75] offset:11264
  v_cvt_pk_bf16_f32 v160, v160, v161
  v_cvt_pk_bf16_f32 v161, v162, v163
  v_cvt_pk_bf16_f32 v162, v184, v185
  v_cvt_pk_bf16_f32 v163, v186, v187
  ds_write_b128 v248, v[160:163] offset:18432
  v_cvt_pk_bf16_f32 v164, v164, v165
  v_cvt_pk_bf16_f32 v165, v166, v167
  v_cvt_pk_bf16_f32 v166, v188, v189
  v_cvt_pk_bf16_f32 v167, v190, v191
  ds_write_b128 v248, v[164:167] offset:19456
  s_setprio 2
  s_waitcnt lgkmcnt(0)
  s_barrier
  .p2align 3
  buffer_store_dwordx4 v[152:155], v253, s[32:35], s49 offen offset:2048 sc1
  buffer_store_dwordx4 v[176:179], v253, s[32:35], s49 offen offset:3072 sc1
  buffer_store_dwordx4 v[160:163], v253, s[32:35], s51 offen offset:2048 sc1
  buffer_store_dwordx4 v[164:167], v253, s[32:35], s51 offen offset:3072 sc1
  v_pk_mul_f32 v[96:97], v[96:97], s[64:65] op_sel_hi:[1,0]
  v_pk_mul_f32 v[98:99], v[98:99], s[64:65] op_sel_hi:[1,0]
  v_pk_mul_f32 v[100:101], v[100:101], s[64:65] op_sel_hi:[1,0]
  v_pk_mul_f32 v[102:103], v[102:103], s[64:65] op_sel_hi:[1,0]
  v_cvt_pk_bf16_f32 v96, v96, v97
  v_cvt_pk_bf16_f32 v97, v98, v99
  v_cvt_pk_bf16_f32 v98, v100, v101
  v_cvt_pk_bf16_f32 v99, v102, v103
  ds_write_b128 v249, v[96:99] offset:0
  v_pk_mul_f32 v[120:121], v[120:121], s[64:65] op_sel_hi:[1,0]
  v_pk_mul_f32 v[122:123], v[122:123], s[64:65] op_sel_hi:[1,0]
  v_pk_mul_f32 v[124:125], v[124:125], s[64:65] op_sel_hi:[1,0]
  v_pk_mul_f32 v[126:127], v[126:127], s[64:65] op_sel_hi:[1,0]
  v_cvt_pk_bf16_f32 v120, v120, v121
  v_cvt_pk_bf16_f32 v121, v122, v123
  v_cvt_pk_bf16_f32 v122, v124, v125
  v_cvt_pk_bf16_f32 v123, v126, v127
  ds_write_b128 v249, v[120:123] offset:1024
  v_pk_mul_f32 v[144:145], v[144:145], s[64:65] op_sel_hi:[1,0]
  v_pk_mul_f32 v[146:147], v[146:147], s[64:65] op_sel_hi:[1,0]
  v_pk_mul_f32 v[148:149], v[148:149], s[64:65] op_sel_hi:[1,0]
  v_pk_mul_f32 v[150:151], v[150:151], s[64:65] op_sel_hi:[1,0]
  v_cvt_pk_bf16_f32 v144, v144, v145
  v_cvt_pk_bf16_f32 v145, v146, v147
  v_cvt_pk_bf16_f32 v146, v148, v149
  v_cvt_pk_bf16_f32 v147, v150, v151
  ds_write_b128 v249, v[144:147] offset:2048
  v_pk_mul_f32 v[168:169], v[168:169], s[64:65] op_sel_hi:[1,0]
  v_pk_mul_f32 v[170:171], v[170:171], s[64:65] op_sel_hi:[1,0]
  v_pk_mul_f32 v[172:173], v[172:173], s[64:65] op_sel_hi:[1,0]
  v_pk_mul_f32 v[174:175], v[174:175], s[64:65] op_sel_hi:[1,0]
  v_cvt_pk_bf16_f32 v168, v168, v169
  v_cvt_pk_bf16_f32 v169, v170, v171
  v_cvt_pk_bf16_f32 v170, v172, v173
  v_cvt_pk_bf16_f32 v171, v174, v175
  ds_write_b128 v249, v[168:171] offset:3072
  s_nop 1
  .p2align 3
  v_mov_b32 v244, 0xf149f2ca
  s_mov_b32 s64, 0xffffffff
  s_mov_b32 s65, 0xff00ff00
  v_cndmask_b32_e64 v120, v244, 0, s[64:65]
  v_cndmask_b32_e64 v136, 0, v244, s[64:65]
  s_mov_b32 s66, 0xfffffffe
  s_mov_b32 s67, 0xff00fe00
  v_cndmask_b32_e64 v121, v244, 0, s[66:67]
  v_cndmask_b32_e64 v137, 0, v244, s[66:67]
  s_mov_b32 s64, 0xfffffffc
  s_mov_b32 s65, 0xff00fc00
  v_cndmask_b32_e64 v122, v244, 0, s[64:65]
  v_cndmask_b32_e64 v138, 0, v244, s[64:65]
  s_mov_b32 s66, 0xfffffff8
  s_mov_b32 s67, 0xff00f800
  v_cndmask_b32_e64 v123, v244, 0, s[66:67]
  v_cndmask_b32_e64 v139, 0, v244, s[66:67]
  s_mov_b32 s64, 0xfffffff0
  s_mov_b32 s65, 0xff00f000
  v_cndmask_b32_e64 v124, v244, 0, s[64:65]
  v_cndmask_b32_e64 v140, 0, v244, s[64:65]
  s_mov_b32 s66, 0xffffffe0
  s_mov_b32 s67, 0xff00e000
  v_cndmask_b32_e64 v125, v244, 0, s[66:67]
  v_cndmask_b32_e64 v141, 0, v244, s[66:67]
  s_mov_b32 s64, 0xffffffc0
  s_mov_b32 s65, 0xff00c000
  v_cndmask_b32_e64 v126, v244, 0, s[64:65]
  v_cndmask_b32_e64 v142, 0, v244, s[64:65]
  s_mov_b32 s66, 0xffffff80
  s_mov_b32 s67, 0xff008000
  v_cndmask_b32_e64 v127, v244, 0, s[66:67]
  v_cndmask_b32_e64 v143, 0, v244, s[66:67]
  s_mov_b32 s64, 0xffffff00
  s_mov_b32 s65, 0xff000000
  v_cndmask_b32_e64 v128, v244, 0, s[64:65]
  v_cndmask_b32_e64 v144, 0, v244, s[64:65]
  s_mov_b32 s66, 0xfffeff00
  s_mov_b32 s67, 0xfe000000
  v_cndmask_b32_e64 v129, v244, 0, s[66:67]
  v_cndmask_b32_e64 v145, 0, v244, s[66:67]
  s_mov_b32 s64, 0xfffcff00
  s_mov_b32 s65, 0xfc000000
  v_cndmask_b32_e64 v130, v244, 0, s[64:65]
  v_cndmask_b32_e64 v146, 0, v244, s[64:65]
  s_mov_b32 s66, 0xfff8ff00
  s_mov_b32 s67, 0xf8000000
  v_cndmask_b32_e64 v131, v244, 0, s[66:67]
  v_cndmask_b32_e64 v147, 0, v244, s[66:67]
  s_mov_b32 s64, 0xfff0ff00
  s_mov_b32 s65, 0xf0000000
  v_cndmask_b32_e64 v132, v244, 0, s[64:65]
  v_cndmask_b32_e64 v148, 0, v244, s[64:65]
  s_mov_b32 s66, 0xffe0ff00
  s_mov_b32 s67, 0xe0000000
  v_cndmask_b32_e64 v133, v244, 0, s[66:67]
  v_cndmask_b32_e64 v149, 0, v244, s[66:67]
  s_mov_b32 s64, 0xffc0ff00
  s_mov_b32 s65, 0xc0000000
  v_cndmask_b32_e64 v134, v244, 0, s[64:65]
  v_cndmask_b32_e64 v150, 0, v244, s[64:65]
  s_mov_b32 s66, 0xff80ff00
  s_mov_b32 s67, 0x80000000
  v_cndmask_b32_e64 v135, v244, 0, s[66:67]
  v_cndmask_b32_e64 v151, 0, v244, s[66:67]
  v_bfe_u32 v244, v252, 2, 1
  v_mul_u32_u24 v154, 0x3f80, v244
  v_lshl_add_u32 v154, v154, 16, v154
  v_xor_b32 v152, 0x3f803f80, v154
  v_mov_b32 v155, v154
  v_mov_b32 v153, v152
  v_pk_mul_f32 v[64:65], 0, 0
  v_pk_mul_f32 v[66:67], 0, 0
  v_mov_b32 v242, 0xdddddddd
  v_and_b32 v157, 3, v252
  v_lshlrev_b32 v157, 4, v157
  v_lshl_add_u32 v157, v244, 10, v157
  v_lshrrev_b32 v244, 3, v252
  v_lshl_add_u32 v157, v244, 6, v157
  v_and_b32 v156, 7, v252
  v_lshlrev_b32 v156, 4, v156
  v_lshrrev_b32 v244, 4, v252
  v_lshl_add_u32 v156, v244, 7, v156
  v_bfe_u32 v244, v252, 3, 1
  v_lshl_add_u32 v156, v244, 10, v156
  s_and_b32 s46, s40, 1
  s_lshl_b32 s72, s46, 15
  s_and_b32 s46, s40, 2
  s_sub_u32 s70, 6, s46
  s_cmp_lt_u32 s40, 4
  s_cselect_b32 s70, s46, s70
  s_add_u32 s71, s70, 1
  s_lshl_b32 s46, s41, 5
  s_add_u32 s46, s46, s42
  s_lshl_b32 s46, s46, 1
  s_and_b32 s73, s40, 1
  s_add_u32 s46, s46, s73
  s_add_u32 s46, s46, 32
  s_mul_i32 s46, s46, 16384
  s_lshl_b32 s73, s70, 11
  s_add_u32 s73, s73, s46

  v_mfma_f32_32x32x16_bf16 v[72:87], v[64:67], v[64:67], 0
  v_mfma_f32_16x16x32_bf16 v[88:91], v[64:67], v[64:67], 0
  v_mfma_f32_32x32x16_bf16 v[100:115], v[64:67], v[64:67], 0
  v_mfma_f32_16x16x32_bf16 v[116:119], v[64:67], v[64:67], 0
  s_lshl_b32 s46, s40, 7
  s_add_u32 s46, s46, s63
  v_mov_b32 v244, 1
  v_lshlrev_b32 v245, 2, v252
  s_mov_b32 exec_hi, 0
  s_waitcnt vmcnt(0)
  buffer_store_dword v244, v245, s[32:35], s46 offen sc1
  s_mov_b32 exec_hi, -1

  s_cmp_ge_u32 s40, 2
  s_cbranch_scc1 L_bnopoll
  s_cmp_eq_u32 s41, 0
  s_cbranch_scc1 L_bnopoll
  s_sub_u32 s46, s46, 2048
  s_mov_b32 s48, 20000
  v_and_b32 v17, 1, v252
  v_lshlrev_b32 v17, 8, v17
  s_lshl_b32 s47, s42, 3
  s_add_u32 s47, s47, s41
  s_mul_i32 s47, s47, 66816
  s_add_u32 s47, s47, s72
  s_add_u32 s47, s47, 10418944
  v_lshlrev_b32 v244, 4, v252

L_bpoll_l:
  buffer_load_dword v16, v17, s[32:35], s46 offen sc1
  s_sub_u32 s48, s48, 1
  s_cmp_eq_u32 s48, 0
  s_cbranch_scc1 L_bpoll_d
  s_waitcnt vmcnt(0)
  v_cmp_ne_u32 vcc, 1, v16
  s_cbranch_vccnz L_bpoll_l

L_bpoll_d:
  s_mov_b32 m0, s72
  s_mov_b32 s48, 8
L_bdma:
  buffer_load_dwordx4 v244, s[32:35], s47 offen offset:0 sc1 lds
  buffer_load_dwordx4 v244, s[32:35], s47 offen offset:1024 sc1 lds
  buffer_load_dwordx4 v244, s[32:35], s47 offen offset:2048 sc1 lds
  buffer_load_dwordx4 v244, s[32:35], s47 offen offset:3072 sc1 lds
  s_add_u32 m0, m0, 4096
  s_add_u32 s47, s47, 4096
  s_sub_u32 s48, s48, 1
  s_cmp_lg_u32 s48, 0
  s_cbranch_scc1 L_bdma

L_bnopoll:
  s_setprio 0
L_battn1:
  s_lshr_b32 s46, s72, 1
  s_add_u32 s46, s46, 131072
  s_lshl_b32 s47, s70, 11
  s_add_u32 s47, s47, s46
  v_add_u32 v158, s47, v156
  ds_read_b128 v[92:95], v158 offset:2048
  ds_read_b128 v[96:99], v158 offset:2560
  ds_read_b128 v[64:67], v158
  ds_read_b128 v[68:71], v158 offset:512

  s_add_u32 s46, s70, 32
  s_mov_b32 s50, s70
  s_lshl_b32 s46, s46, 11
  s_add_u32 s46, s46, s72
  v_add_u32 v159, s46, v157
  v_add_u32 v244, 2048, v159
  ds_read_b128 v[32:35], v244
  ds_read_b128 v[36:39], v244 offset:512
  v_add_u32 v158, s46, v156
  ds_read_b128 v[48:51], v159
  ds_read_b128 v[52:55], v159 offset:512
  ds_read_b128 v[56:59], v158 offset:18432
  ds_read_b128 v[60:63], v158 offset:18944
  s_waitcnt lgkmcnt(5)
  v_mfma_f32_32x32x16_bf16 v[16:31], v[32:35], v[92:95], v[120:135]
  s_waitcnt lgkmcnt(4)
  v_mfma_f32_32x32x16_bf16 v[16:31], v[36:39], v[96:99], v[16:31]
  s_waitcnt lgkmcnt(0)
  s_nop 7
  s_nop 1

  v_mfma_f32_32x32x16_bf16 v[0:15], v[48:51], v[64:67], v[120:135]
  v_exp_f32 v32, v16
  v_exp_f32 v33, v17
  v_exp_f32 v34, v18
  v_mfma_f32_32x32x16_bf16 v[0:15], v[52:55], v[68:71], v[0:15]
  v_exp_f32 v35, v19
  v_exp_f32 v36, v20
  v_exp_f32 v37, v21
  v_exp_f32 v38, v22
  v_exp_f32 v39, v23
  v_exp_f32 v40, v24
  v_exp_f32 v41, v25
  v_smfmac_f32_32x32x32_bf16 v[100:115], v[56:59], v[32:39], v242
  ds_read_b128 v[56:59], v158 offset:16384
  v_exp_f32 v42, v26
  v_exp_f32 v43, v27
  v_exp_f32 v44, v28
  v_smfmac_f32_16x16x64_bf16 v[116:119], v[152:155], v[32:39], v242
  v_exp_f32 v45, v29
  v_exp_f32 v46, v30
  v_exp_f32 v47, v31
L_pair_own:
  v_mfma_f32_32x32x16_bf16 v[16:31], v[48:51], v[92:95], 0
  v_add_u32 v159, 4294965248, v159
  v_exp_f32 v32, v0
  v_exp_f32 v33, v1
  v_exp_f32 v34, v2
  v_mfma_f32_32x32x16_bf16 v[16:31], v[52:55], v[96:99], v[16:31]
  ds_read_b128 v[48:51], v159
  ds_read_b128 v[52:55], v159 offset:512
  v_exp_f32 v35, v3
  v_exp_f32 v36, v4
  v_exp_f32 v37, v5
  v_smfmac_f32_16x16x64_bf16 v[116:119], v[152:155], v[40:47], v242
  v_exp_f32 v38, v6
  v_smfmac_f32_32x32x32_bf16 v[100:115], v[60:63], v[40:47], v242
  ds_read_b128 v[60:63], v158 offset:16896
  v_exp_f32 v39, v7
  v_exp_f32 v40, v8
  v_exp_f32 v41, v9
  s_waitcnt lgkmcnt(3)
  v_smfmac_f32_32x32x32_bf16 v[72:87], v[56:59], v[32:39], v242
  v_exp_f32 v42, v10
  v_exp_f32 v43, v11
  v_exp_f32 v44, v12
  v_smfmac_f32_16x16x64_bf16 v[88:91], v[152:155], v[32:39], v242
  v_exp_f32 v45, v13
  v_exp_f32 v46, v14
  v_exp_f32 v47, v15
  s_waitcnt lgkmcnt(0)
  v_mfma_f32_32x32x16_bf16 v[0:15], v[48:51], v[64:67], 0
  v_exp_f32 v32, v16
  v_exp_f32 v33, v17
  v_exp_f32 v34, v18
  v_mfma_f32_32x32x16_bf16 v[0:15], v[52:55], v[68:71], v[0:15]
  v_exp_f32 v35, v19
  v_exp_f32 v36, v20
  v_exp_f32 v37, v21
  v_smfmac_f32_16x16x64_bf16 v[88:91], v[152:155], v[40:47], v242
  v_exp_f32 v38, v22
  v_smfmac_f32_32x32x32_bf16 v[72:87], v[60:63], v[40:47], v242
  v_add_u32 v158, 4294965248, v158
  v_exp_f32 v39, v23
  v_exp_f32 v40, v24
  v_exp_f32 v41, v25
  v_smfmac_f32_32x32x32_bf16 v[100:115], v[56:59], v[32:39], v242
  ds_read_b128 v[56:59], v158 offset:16384
  v_exp_f32 v42, v26
  v_exp_f32 v43, v27
  v_exp_f32 v44, v28
  v_smfmac_f32_16x16x64_bf16 v[116:119], v[152:155], v[32:39], v242
  v_exp_f32 v45, v29
  v_exp_f32 v46, v30
  s_sub_u32 s50, s50, 1
  v_exp_f32 v47, v31
  s_cbranch_scc0 L_pair_own
  s_nop 0
  v_smfmac_f32_32x32x32_bf16 v[100:115], v[60:63], v[40:47], v242
  v_smfmac_f32_16x16x64_bf16 v[116:119], v[152:155], v[40:47], v242

  s_cmp_ge_u32 s40, 4
  s_cbranch_scc1 L_nofsetup
  v_lshlrev_b32 v224, 4, v252
  v_lshrrev_b32 v230, 2, v252
  v_lshlrev_b32 v230, 7, v230
  v_bfe_u32 v231, v252, 3, 2
  v_lshl_add_u32 v230, v231, 5, v230
  v_and_b32 v231, 3, v252
  v_lshl_add_u32 v230, v231, 3, v230
  v_add_u32 v226, 65536, v230
  v_xor_b32 v227, 32, v226
  v_xor_b32 v228, 64, v226
  v_xor_b32 v229, 96, v226

  s_mul_i32 s59, s78, 1048576
  s_add_u32 s26, s59, 1048576
  s_lshl_b32 s47, s77, 13
  s_add_u32 s59, s59, s47
  s_lshl_b32 s47, s40, 11
  s_add_u32 s59, s59, s47
  v_mov_b32 v230, 0
  v_mov_b32 v231, 0
  v_mov_b32 v232, 0
  v_mov_b32 v233, 0
  s_mov_b32 s28, s18
  s_and_b32 s29, s19, 0xffff
  s_mov_b32 s30, 0x400000
  s_mov_b32 s53, 32768
  s_mov_b32 s24, s32
  s_mov_b32 s25, s33
  s_movk_i32 s61, 0x108

L_nofsetup:
  s_setprio 0
  s_waitcnt vmcnt(0) lgkmcnt(0)
  s_barrier
  s_cmp_lt_u32 s40, 4
  s_cbranch_scc1 L_nofill
  s_setprio 1

  s_cmp_ge_u32 s40, 6
  s_cbranch_scc1 L_nofill
  s_mov_b32 s49, 12
  s_mov_b32 s90, 0
L_fillB:
  s_lshl_b32 s57, s90, 17
  s_xor_b32 s57, s57, s75
  s_mov_b32 m0, s91
  s_add_u32 s91, s91, 8192
  s_add_u32 s90, s90, 1
  buffer_load_dwordx4 v240, s[80:83], s57 offen lds
  buffer_load_dwordx4 v241, s[80:83], s57 offen offset:1024 lds

  s_add_u32 m0, m0, 4096
  s_add_u32 s57, s57, 65536
  buffer_load_dwordx4 v240, s[80:83], s57 offen lds
  buffer_load_dwordx4 v241, s[80:83], s57 offen offset:1024 lds

  s_sub_u32 s49, s49, 1
  s_cmp_lg_u32 s49, 0
  s_cbranch_scc1 L_fillB

L_nofill:
  s_cmp_eq_u32 s41, 0
  s_cbranch_scc0 L_bhalo
  s_nop 7
  s_branch L_bfin
L_bhalo:

  s_add_u32 s46, s70, 1
  s_sub_u32 s50, 6, s70
  s_lshl_b32 s46, s46, 11
  s_add_u32 s46, s46, s72
  v_add_u32 v159, s46, v157
  v_add_u32 v244, 4294965248, v159
  ds_read_b128 v[32:35], v244
  ds_read_b128 v[36:39], v244 offset:512
  v_add_u32 v158, s46, v156
  ds_read_b128 v[48:51], v159
  ds_read_b128 v[52:55], v159 offset:512
  ds_read_b128 v[56:59], v158 offset:14336
  ds_read_b128 v[60:63], v158 offset:14848
  s_waitcnt lgkmcnt(5)
  v_mfma_f32_32x32x16_bf16 v[0:15], v[32:35], v[64:67], v[136:151]
  s_waitcnt lgkmcnt(4)
  v_mfma_f32_32x32x16_bf16 v[0:15], v[36:39], v[68:71], v[0:15]
  s_waitcnt lgkmcnt(0)
  s_nop 7
  s_nop 1

  v_mfma_f32_32x32x16_bf16 v[16:31], v[48:51], v[92:95], v[136:151]
  v_exp_f32 v32, v0
  v_exp_f32 v33, v1
  v_exp_f32 v34, v2
  v_mfma_f32_32x32x16_bf16 v[16:31], v[52:55], v[96:99], v[16:31]
  v_exp_f32 v35, v3
  v_exp_f32 v36, v4
  v_exp_f32 v37, v5
  v_exp_f32 v38, v6
  v_exp_f32 v39, v7
  v_exp_f32 v40, v8
  v_exp_f32 v41, v9
  v_smfmac_f32_32x32x32_bf16 v[72:87], v[56:59], v[32:39], v242
  ds_read_b128 v[56:59], v158 offset:16384
  v_exp_f32 v42, v10
  v_exp_f32 v43, v11
  v_exp_f32 v44, v12
  v_smfmac_f32_16x16x64_bf16 v[88:91], v[152:155], v[32:39], v242
  v_exp_f32 v45, v13
  v_exp_f32 v46, v14
  v_exp_f32 v47, v15
L_pair_halo:
  v_mfma_f32_32x32x16_bf16 v[0:15], v[48:51], v[64:67], 0
  v_add_u32 v159, 2048, v159
  v_exp_f32 v32, v16
  v_exp_f32 v33, v17
  v_exp_f32 v34, v18
  v_mfma_f32_32x32x16_bf16 v[0:15], v[52:55], v[68:71], v[0:15]
  ds_read_b128 v[48:51], v159
  ds_read_b128 v[52:55], v159 offset:512
  v_exp_f32 v35, v19
  v_exp_f32 v36, v20
  v_exp_f32 v37, v21
  v_smfmac_f32_16x16x64_bf16 v[88:91], v[152:155], v[40:47], v242
  v_exp_f32 v38, v22
  v_smfmac_f32_32x32x32_bf16 v[72:87], v[60:63], v[40:47], v242
  ds_read_b128 v[60:63], v158 offset:16896
  v_exp_f32 v39, v23
  v_exp_f32 v40, v24
  v_exp_f32 v41, v25
  s_waitcnt lgkmcnt(3)
  v_smfmac_f32_32x32x32_bf16 v[100:115], v[56:59], v[32:39], v242
  v_exp_f32 v42, v26
  v_exp_f32 v43, v27
  v_exp_f32 v44, v28
  v_smfmac_f32_16x16x64_bf16 v[116:119], v[152:155], v[32:39], v242
  v_exp_f32 v45, v29
  v_exp_f32 v46, v30
  v_exp_f32 v47, v31
  s_waitcnt lgkmcnt(0)
  v_mfma_f32_32x32x16_bf16 v[16:31], v[48:51], v[92:95], 0
  v_exp_f32 v32, v0
  v_exp_f32 v33, v1
  v_exp_f32 v34, v2
  v_mfma_f32_32x32x16_bf16 v[16:31], v[52:55], v[96:99], v[16:31]
  v_exp_f32 v35, v3
  v_exp_f32 v36, v4
  v_exp_f32 v37, v5
  v_smfmac_f32_16x16x64_bf16 v[116:119], v[152:155], v[40:47], v242
  v_exp_f32 v38, v6
  v_smfmac_f32_32x32x32_bf16 v[100:115], v[60:63], v[40:47], v242
  v_add_u32 v158, 2048, v158
  v_exp_f32 v39, v7
  v_exp_f32 v40, v8
  v_exp_f32 v41, v9
  v_smfmac_f32_32x32x32_bf16 v[72:87], v[56:59], v[32:39], v242
  ds_read_b128 v[56:59], v158 offset:16384
  v_exp_f32 v42, v10
  v_exp_f32 v43, v11
  v_exp_f32 v44, v12
  v_smfmac_f32_16x16x64_bf16 v[88:91], v[152:155], v[32:39], v242
  v_exp_f32 v45, v13
  v_exp_f32 v46, v14
  s_sub_u32 s50, s50, 1
  v_exp_f32 v47, v15
  s_cbranch_scc0 L_pair_halo
  s_nop 0
  v_smfmac_f32_32x32x32_bf16 v[72:87], v[60:63], v[40:47], v242
  v_smfmac_f32_16x16x64_bf16 v[88:91], v[152:155], v[40:47], v242

L_bfin:
  s_waitcnt lgkmcnt(0)
  s_nop 1
  v_subrev_u32 v244, 0x2b800000, v116
  v_cmp_lt_u32 vcc, 0x28000000, v244
  s_cbranch_vccnz L_slow_b

  .p2align 3
L_back_b:
  v_rcp_f32 v244, v116
  s_nop 0
  v_pk_mul_f32 v[100:101], v[100:101], v[244:245] op_sel_hi:[1,0]
  v_pk_mul_f32 v[102:103], v[102:103], v[244:245] op_sel_hi:[1,0]
  v_pk_mul_f32 v[104:105], v[104:105], v[244:245] op_sel_hi:[1,0]
  v_pk_mul_f32 v[106:107], v[106:107], v[244:245] op_sel_hi:[1,0]
  v_pk_mul_f32 v[108:109], v[108:109], v[244:245] op_sel_hi:[1,0]
  v_pk_mul_f32 v[110:111], v[110:111], v[244:245] op_sel_hi:[1,0]
  v_pk_mul_f32 v[112:113], v[112:113], v[244:245] op_sel_hi:[1,0]
  v_pk_mul_f32 v[114:115], v[114:115], v[244:245] op_sel_hi:[1,0]
  v_cvt_pk_bf16_f32 v100, v100, v101
  v_cvt_pk_bf16_f32 v101, v102, v103
  v_cvt_pk_bf16_f32 v102, v104, v105
  v_cvt_pk_bf16_f32 v103, v106, v107
  v_cvt_pk_bf16_f32 v104, v108, v109
  v_cvt_pk_bf16_f32 v105, v110, v111
  v_cvt_pk_bf16_f32 v106, v112, v113
  v_cvt_pk_bf16_f32 v107, v114, v115
  buffer_store_dwordx4 v[100:103], v156, s[32:35], s73 offen offset:2048 sc1
  buffer_store_dwordx4 v[104:107], v156, s[32:35], s73 offen offset:2560 sc1
  v_subrev_u32 v244, 0x2b800000, v88
  v_cmp_lt_u32 vcc, 0x28000000, v244
  s_cbranch_vccnz L_slow_a

  .p2align 3
L_back_a:
  v_rcp_f32 v244, v88
  s_nop 0
  v_pk_mul_f32 v[72:73], v[72:73], v[244:245] op_sel_hi:[1,0]
  v_pk_mul_f32 v[74:75], v[74:75], v[244:245] op_sel_hi:[1,0]
  v_pk_mul_f32 v[76:77], v[76:77], v[244:245] op_sel_hi:[1,0]
  v_pk_mul_f32 v[78:79], v[78:79], v[244:245] op_sel_hi:[1,0]
  v_pk_mul_f32 v[80:81], v[80:81], v[244:245] op_sel_hi:[1,0]
  v_pk_mul_f32 v[82:83], v[82:83], v[244:245] op_sel_hi:[1,0]
  v_pk_mul_f32 v[84:85], v[84:85], v[244:245] op_sel_hi:[1,0]
  v_pk_mul_f32 v[86:87], v[86:87], v[244:245] op_sel_hi:[1,0]
  v_cvt_pk_bf16_f32 v72, v72, v73
  v_cvt_pk_bf16_f32 v73, v74, v75
  v_cvt_pk_bf16_f32 v74, v76, v77
  v_cvt_pk_bf16_f32 v75, v78, v79
  v_cvt_pk_bf16_f32 v76, v80, v81
  v_cvt_pk_bf16_f32 v77, v82, v83
  v_cvt_pk_bf16_f32 v78, v84, v85
  v_cvt_pk_bf16_f32 v79, v86, v87
  buffer_store_dwordx4 v[72:75], v156, s[32:35], s73 offen offset:0 sc1
  buffer_store_dwordx4 v[76:79], v156, s[32:35], s73 offen offset:512 sc1
  s_cmp_ge_u32 s40, 4
  s_cbranch_scc1 L_fprod

  s_barrier
  buffer_load_dwordx4 v[160:163], v224, s[24:27], s59 offen offset:0 sc1
  buffer_load_dwordx4 v[164:167], v224, s[24:27], s59 offen offset:1024 sc1
  s_add_u32 s59, s59, 16384
  buffer_load_dwordx4 v[168:171], v224, s[24:27], s59 offen offset:0 sc1
  buffer_load_dwordx4 v[172:175], v224, s[24:27], s59 offen offset:1024 sc1
  s_add_u32 s59, s59, 16384
  buffer_load_dwordx4 v[176:179], v224, s[24:27], s59 offen offset:0 sc1
  buffer_load_dwordx4 v[180:183], v224, s[24:27], s59 offen offset:1024 sc1
  s_add_u32 s59, s59, 16384
  buffer_load_dwordx4 v[184:187], v224, s[24:27], s59 offen offset:0 sc1
  buffer_load_dwordx4 v[188:191], v224, s[24:27], s59 offen offset:1024 sc1
  s_add_u32 s59, s59, 16384
  buffer_load_dwordx4 v[192:195], v224, s[24:27], s59 offen offset:0 sc1
  buffer_load_dwordx4 v[196:199], v224, s[24:27], s59 offen offset:1024 sc1
  s_add_u32 s59, s59, 16384
  buffer_load_dwordx4 v[200:203], v224, s[24:27], s59 offen offset:0 sc1
  buffer_load_dwordx4 v[204:207], v224, s[24:27], s59 offen offset:1024 sc1
  s_add_u32 s59, s59, 16384
  buffer_load_dwordx4 v[208:211], v224, s[24:27], s59 offen offset:0 sc1
  buffer_load_dwordx4 v[212:215], v224, s[24:27], s59 offen offset:1024 sc1
  s_add_u32 s59, s59, 16384
  s_branch L_fcons
L_slow_a:
  s_nop 7
  s_nop 7

  v_pk_mul_f32 v[72:73], 0, 0
  v_pk_mul_f32 v[74:75], 0, 0
  v_pk_mul_f32 v[76:77], 0, 0
  v_pk_mul_f32 v[78:79], 0, 0
  v_pk_mul_f32 v[80:81], 0, 0
  v_pk_mul_f32 v[82:83], 0, 0
  v_pk_mul_f32 v[84:85], 0, 0
  v_pk_mul_f32 v[86:87], 0, 0
  v_pk_mul_f32 v[88:89], 0, 0
  v_pk_mul_f32 v[90:91], 0, 0
  v_mov_b32 v246, 0xff61b1e6
  s_add_u32 s52, s70, 8

  s_cmp_eq_u32 s41, 0
  s_cselect_b32 s51, 8, s70

L_slowl_a0:
  s_lshl_b32 s46, s42, 3
  s_add_u32 s46, s46, s41
  s_lshr_b32 s47, s51, 3
  s_add_u32 s46, s46, s47
  s_mul_i32 s46, s46, 66816
  s_and_b32 s47, s51, 7
  s_lshl_b32 s47, s47, 11
  s_add_u32 s46, s46, s47
  s_add_u32 s46, s46, s72
  s_add_u32 s46, s46, 10418944
  s_add_u32 s47, s46, 16384
  buffer_load_dwordx4 v[48:51], v157, s[32:35], s46 offen sc1
  buffer_load_dwordx4 v[52:55], v157, s[32:35], s46 offen offset:512 sc1
  buffer_load_dwordx4 v[56:59], v156, s[32:35], s47 offen sc1
  buffer_load_dwordx4 v[60:63], v156, s[32:35], s47 offen offset:512 sc1
  s_cmp_eq_u32 s51, s52
  s_cselect_b32 s47, 1.0, 0
  s_cmp_eq_u32 s51, s70
  s_cselect_b32 s48, 1.0, 0

  v_mul_f32 v16, s47, v120
  v_fmac_f32 v16, s48, v136
  v_mul_f32 v17, s47, v121
  v_fmac_f32 v17, s48, v137
  v_mul_f32 v18, s47, v122
  v_fmac_f32 v18, s48, v138
  v_mul_f32 v19, s47, v123
  v_fmac_f32 v19, s48, v139
  v_mul_f32 v20, s47, v124
  v_fmac_f32 v20, s48, v140
  v_mul_f32 v21, s47, v125
  v_fmac_f32 v21, s48, v141
  v_mul_f32 v22, s47, v126
  v_fmac_f32 v22, s48, v142
  v_mul_f32 v23, s47, v127
  v_fmac_f32 v23, s48, v143
  v_mul_f32 v24, s47, v128
  v_fmac_f32 v24, s48, v144
  v_mul_f32 v25, s47, v129
  v_fmac_f32 v25, s48, v145
  v_mul_f32 v26, s47, v130
  v_fmac_f32 v26, s48, v146
  v_mul_f32 v27, s47, v131
  v_fmac_f32 v27, s48, v147
  v_mul_f32 v28, s47, v132
  v_fmac_f32 v28, s48, v148
  v_mul_f32 v29, s47, v133
  v_fmac_f32 v29, s48, v149
  v_mul_f32 v30, s47, v134
  v_fmac_f32 v30, s48, v150
  v_mul_f32 v31, s47, v135
  v_fmac_f32 v31, s48, v151
  s_waitcnt vmcnt(0)
  s_nop 1
  v_mfma_f32_32x32x16_bf16 v[0:15], v[48:51], v[64:67], v[16:31]
  v_mfma_f32_32x32x16_bf16 v[0:15], v[52:55], v[68:71], v[0:15]
  s_nop 7
  s_nop 7

  v_max3_f32 v246, v0, v1, v246
  v_max3_f32 v246, v2, v3, v246
  v_max3_f32 v246, v4, v5, v246
  v_max3_f32 v246, v6, v7, v246
  v_max3_f32 v246, v8, v9, v246
  v_max3_f32 v246, v10, v11, v246
  v_max3_f32 v246, v12, v13, v246
  v_max3_f32 v246, v14, v15, v246
  s_add_u32 s51, s51, 1
  s_cmp_le_u32 s51, s52
  s_cbranch_scc1 L_slowl_a0

  v_mov_b32 v247, v246
  s_nop 1
  v_permlane32_swap_b32 v246, v247
  s_nop 1
  v_max_f32 v246, v246, v247

  s_cmp_eq_u32 s41, 0
  s_cselect_b32 s51, 8, s70

L_slowl_a1:
  s_lshl_b32 s46, s42, 3
  s_add_u32 s46, s46, s41
  s_lshr_b32 s47, s51, 3
  s_add_u32 s46, s46, s47
  s_mul_i32 s46, s46, 66816
  s_and_b32 s47, s51, 7
  s_lshl_b32 s47, s47, 11
  s_add_u32 s46, s46, s47
  s_add_u32 s46, s46, s72
  s_add_u32 s46, s46, 10418944
  s_add_u32 s47, s46, 16384
  buffer_load_dwordx4 v[48:51], v157, s[32:35], s46 offen sc1
  buffer_load_dwordx4 v[52:55], v157, s[32:35], s46 offen offset:512 sc1
  buffer_load_dwordx4 v[56:59], v156, s[32:35], s47 offen sc1
  buffer_load_dwordx4 v[60:63], v156, s[32:35], s47 offen offset:512 sc1
  s_cmp_eq_u32 s51, s52
  s_cselect_b32 s47, 1.0, 0
  s_cmp_eq_u32 s51, s70
  s_cselect_b32 s48, 1.0, 0

  v_mul_f32 v16, s47, v120
  v_fmac_f32 v16, s48, v136
  v_mul_f32 v17, s47, v121
  v_fmac_f32 v17, s48, v137
  v_mul_f32 v18, s47, v122
  v_fmac_f32 v18, s48, v138
  v_mul_f32 v19, s47, v123
  v_fmac_f32 v19, s48, v139
  v_mul_f32 v20, s47, v124
  v_fmac_f32 v20, s48, v140
  v_mul_f32 v21, s47, v125
  v_fmac_f32 v21, s48, v141
  v_mul_f32 v22, s47, v126
  v_fmac_f32 v22, s48, v142
  v_mul_f32 v23, s47, v127
  v_fmac_f32 v23, s48, v143
  v_mul_f32 v24, s47, v128
  v_fmac_f32 v24, s48, v144
  v_mul_f32 v25, s47, v129
  v_fmac_f32 v25, s48, v145
  v_mul_f32 v26, s47, v130
  v_fmac_f32 v26, s48, v146
  v_mul_f32 v27, s47, v131
  v_fmac_f32 v27, s48, v147
  v_mul_f32 v28, s47, v132
  v_fmac_f32 v28, s48, v148
  v_mul_f32 v29, s47, v133
  v_fmac_f32 v29, s48, v149
  v_mul_f32 v30, s47, v134
  v_fmac_f32 v30, s48, v150
  v_mul_f32 v31, s47, v135
  v_fmac_f32 v31, s48, v151
  s_waitcnt vmcnt(0)
  s_nop 1
  v_mfma_f32_32x32x16_bf16 v[0:15], v[48:51], v[64:67], v[16:31]
  v_mfma_f32_32x32x16_bf16 v[0:15], v[52:55], v[68:71], v[0:15]
  s_nop 7
  s_nop 7

  v_sub_f32 v0, v0, v246
  v_sub_f32 v1, v1, v246
  v_sub_f32 v2, v2, v246
  v_sub_f32 v3, v3, v246
  v_sub_f32 v4, v4, v246
  v_sub_f32 v5, v5, v246
  v_sub_f32 v6, v6, v246
  v_sub_f32 v7, v7, v246
  v_sub_f32 v8, v8, v246
  v_sub_f32 v9, v9, v246
  v_sub_f32 v10, v10, v246
  v_sub_f32 v11, v11, v246
  v_sub_f32 v12, v12, v246
  v_sub_f32 v13, v13, v246
  v_sub_f32 v14, v14, v246
  v_sub_f32 v15, v15, v246
  v_exp_f32 v32, v0
  v_exp_f32 v33, v1
  v_exp_f32 v34, v2
  v_exp_f32 v35, v3
  v_exp_f32 v36, v4
  v_exp_f32 v37, v5
  v_exp_f32 v38, v6
  v_exp_f32 v39, v7
  v_exp_f32 v40, v8
  v_exp_f32 v41, v9
  v_exp_f32 v42, v10
  v_exp_f32 v43, v11
  v_exp_f32 v44, v12
  v_exp_f32 v45, v13
  v_exp_f32 v46, v14
  v_exp_f32 v47, v15
  s_nop 1
  v_smfmac_f32_32x32x32_bf16 v[72:87], v[56:59], v[32:39], v242
  v_smfmac_f32_32x32x32_bf16 v[72:87], v[60:63], v[40:47], v242
  v_smfmac_f32_16x16x64_bf16 v[88:91], v[152:155], v[32:39], v242
  v_smfmac_f32_16x16x64_bf16 v[88:91], v[152:155], v[40:47], v242
  s_add_u32 s51, s51, 1
  s_cmp_le_u32 s51, s52
  s_cbranch_scc1 L_slowl_a1

  s_nop 7
  s_nop 7
  s_branch L_back_a
L_slow_b:
  s_nop 7
  s_nop 7

  v_pk_mul_f32 v[100:101], 0, 0
  v_pk_mul_f32 v[102:103], 0, 0
  v_pk_mul_f32 v[104:105], 0, 0
  v_pk_mul_f32 v[106:107], 0, 0
  v_pk_mul_f32 v[108:109], 0, 0
  v_pk_mul_f32 v[110:111], 0, 0
  v_pk_mul_f32 v[112:113], 0, 0
  v_pk_mul_f32 v[114:115], 0, 0
  v_pk_mul_f32 v[116:117], 0, 0
  v_pk_mul_f32 v[118:119], 0, 0
  v_mov_b32 v246, 0xff61b1e6
  s_add_u32 s52, s71, 8

  s_cmp_eq_u32 s41, 0
  s_cselect_b32 s51, 8, s71

L_slowl_b0:
  s_lshl_b32 s46, s42, 3
  s_add_u32 s46, s46, s41
  s_lshr_b32 s47, s51, 3
  s_add_u32 s46, s46, s47
  s_mul_i32 s46, s46, 66816
  s_and_b32 s47, s51, 7
  s_lshl_b32 s47, s47, 11
  s_add_u32 s46, s46, s47
  s_add_u32 s46, s46, s72
  s_add_u32 s46, s46, 10418944
  s_add_u32 s47, s46, 16384
  buffer_load_dwordx4 v[48:51], v157, s[32:35], s46 offen sc1
  buffer_load_dwordx4 v[52:55], v157, s[32:35], s46 offen offset:512 sc1
  buffer_load_dwordx4 v[56:59], v156, s[32:35], s47 offen sc1
  buffer_load_dwordx4 v[60:63], v156, s[32:35], s47 offen offset:512 sc1
  s_cmp_eq_u32 s51, s52
  s_cselect_b32 s47, 1.0, 0
  s_cmp_eq_u32 s51, s71
  s_cselect_b32 s48, 1.0, 0

  v_mul_f32 v16, s47, v120
  v_fmac_f32 v16, s48, v136
  v_mul_f32 v17, s47, v121
  v_fmac_f32 v17, s48, v137
  v_mul_f32 v18, s47, v122
  v_fmac_f32 v18, s48, v138
  v_mul_f32 v19, s47, v123
  v_fmac_f32 v19, s48, v139
  v_mul_f32 v20, s47, v124
  v_fmac_f32 v20, s48, v140
  v_mul_f32 v21, s47, v125
  v_fmac_f32 v21, s48, v141
  v_mul_f32 v22, s47, v126
  v_fmac_f32 v22, s48, v142
  v_mul_f32 v23, s47, v127
  v_fmac_f32 v23, s48, v143
  v_mul_f32 v24, s47, v128
  v_fmac_f32 v24, s48, v144
  v_mul_f32 v25, s47, v129
  v_fmac_f32 v25, s48, v145
  v_mul_f32 v26, s47, v130
  v_fmac_f32 v26, s48, v146
  v_mul_f32 v27, s47, v131
  v_fmac_f32 v27, s48, v147
  v_mul_f32 v28, s47, v132
  v_fmac_f32 v28, s48, v148
  v_mul_f32 v29, s47, v133
  v_fmac_f32 v29, s48, v149
  v_mul_f32 v30, s47, v134
  v_fmac_f32 v30, s48, v150
  v_mul_f32 v31, s47, v135
  v_fmac_f32 v31, s48, v151
  s_waitcnt vmcnt(0)
  s_nop 1
  v_mfma_f32_32x32x16_bf16 v[0:15], v[48:51], v[92:95], v[16:31]
  v_mfma_f32_32x32x16_bf16 v[0:15], v[52:55], v[96:99], v[0:15]
  s_nop 7
  s_nop 7

  v_max3_f32 v246, v0, v1, v246
  v_max3_f32 v246, v2, v3, v246
  v_max3_f32 v246, v4, v5, v246
  v_max3_f32 v246, v6, v7, v246
  v_max3_f32 v246, v8, v9, v246
  v_max3_f32 v246, v10, v11, v246
  v_max3_f32 v246, v12, v13, v246
  v_max3_f32 v246, v14, v15, v246
  s_add_u32 s51, s51, 1
  s_cmp_le_u32 s51, s52
  s_cbranch_scc1 L_slowl_b0

  v_mov_b32 v247, v246
  s_nop 1
  v_permlane32_swap_b32 v246, v247
  s_nop 1
  v_max_f32 v246, v246, v247

  s_cmp_eq_u32 s41, 0
  s_cselect_b32 s51, 8, s71

L_slowl_b1:
  s_lshl_b32 s46, s42, 3
  s_add_u32 s46, s46, s41
  s_lshr_b32 s47, s51, 3
  s_add_u32 s46, s46, s47
  s_mul_i32 s46, s46, 66816
  s_and_b32 s47, s51, 7
  s_lshl_b32 s47, s47, 11
  s_add_u32 s46, s46, s47
  s_add_u32 s46, s46, s72
  s_add_u32 s46, s46, 10418944
  s_add_u32 s47, s46, 16384
  buffer_load_dwordx4 v[48:51], v157, s[32:35], s46 offen sc1
  buffer_load_dwordx4 v[52:55], v157, s[32:35], s46 offen offset:512 sc1
  buffer_load_dwordx4 v[56:59], v156, s[32:35], s47 offen sc1
  buffer_load_dwordx4 v[60:63], v156, s[32:35], s47 offen offset:512 sc1
  s_cmp_eq_u32 s51, s52
  s_cselect_b32 s47, 1.0, 0
  s_cmp_eq_u32 s51, s71
  s_cselect_b32 s48, 1.0, 0

  v_mul_f32 v16, s47, v120
  v_fmac_f32 v16, s48, v136
  v_mul_f32 v17, s47, v121
  v_fmac_f32 v17, s48, v137
  v_mul_f32 v18, s47, v122
  v_fmac_f32 v18, s48, v138
  v_mul_f32 v19, s47, v123
  v_fmac_f32 v19, s48, v139
  v_mul_f32 v20, s47, v124
  v_fmac_f32 v20, s48, v140
  v_mul_f32 v21, s47, v125
  v_fmac_f32 v21, s48, v141
  v_mul_f32 v22, s47, v126
  v_fmac_f32 v22, s48, v142
  v_mul_f32 v23, s47, v127
  v_fmac_f32 v23, s48, v143
  v_mul_f32 v24, s47, v128
  v_fmac_f32 v24, s48, v144
  v_mul_f32 v25, s47, v129
  v_fmac_f32 v25, s48, v145
  v_mul_f32 v26, s47, v130
  v_fmac_f32 v26, s48, v146
  v_mul_f32 v27, s47, v131
  v_fmac_f32 v27, s48, v147
  v_mul_f32 v28, s47, v132
  v_fmac_f32 v28, s48, v148
  v_mul_f32 v29, s47, v133
  v_fmac_f32 v29, s48, v149
  v_mul_f32 v30, s47, v134
  v_fmac_f32 v30, s48, v150
  v_mul_f32 v31, s47, v135
  v_fmac_f32 v31, s48, v151
  s_waitcnt vmcnt(0)
  s_nop 1
  v_mfma_f32_32x32x16_bf16 v[0:15], v[48:51], v[92:95], v[16:31]
  v_mfma_f32_32x32x16_bf16 v[0:15], v[52:55], v[96:99], v[0:15]
  s_nop 7
  s_nop 7

  v_sub_f32 v0, v0, v246
  v_sub_f32 v1, v1, v246
  v_sub_f32 v2, v2, v246
  v_sub_f32 v3, v3, v246
  v_sub_f32 v4, v4, v246
  v_sub_f32 v5, v5, v246
  v_sub_f32 v6, v6, v246
  v_sub_f32 v7, v7, v246
  v_sub_f32 v8, v8, v246
  v_sub_f32 v9, v9, v246
  v_sub_f32 v10, v10, v246
  v_sub_f32 v11, v11, v246
  v_sub_f32 v12, v12, v246
  v_sub_f32 v13, v13, v246
  v_sub_f32 v14, v14, v246
  v_sub_f32 v15, v15, v246
  v_exp_f32 v32, v0
  v_exp_f32 v33, v1
  v_exp_f32 v34, v2
  v_exp_f32 v35, v3
  v_exp_f32 v36, v4
  v_exp_f32 v37, v5
  v_exp_f32 v38, v6
  v_exp_f32 v39, v7
  v_exp_f32 v40, v8
  v_exp_f32 v41, v9
  v_exp_f32 v42, v10
  v_exp_f32 v43, v11
  v_exp_f32 v44, v12
  v_exp_f32 v45, v13
  v_exp_f32 v46, v14
  v_exp_f32 v47, v15
  s_nop 1
  v_smfmac_f32_32x32x32_bf16 v[100:115], v[56:59], v[32:39], v242
  v_smfmac_f32_32x32x32_bf16 v[100:115], v[60:63], v[40:47], v242
  v_smfmac_f32_16x16x64_bf16 v[116:119], v[152:155], v[32:39], v242
  v_smfmac_f32_16x16x64_bf16 v[116:119], v[152:155], v[40:47], v242
  s_add_u32 s51, s51, 1
  s_cmp_le_u32 s51, s52
  s_cbranch_scc1 L_slowl_b1

  s_nop 7
  s_nop 7
  s_branch L_back_b
L_consA:
  s_mov_b32 s50, 8
  s_mov_b32 s51, 0
  ds_read_b128 v[192:195], v248 offset:16384
  ds_read_b128 v[196:199], v248 offset:18432
  ds_read_b64_tr_b16 v[224:225], v250 offset:0
  ds_read_b64_tr_b16 v[226:227], v250 offset:512
  ds_read_b128 v[200:203], v248 offset:20480
  ds_read_b128 v[204:207], v248 offset:22528
  ds_read_b64_tr_b16 v[228:229], v251 offset:0
  ds_read_b64_tr_b16 v[230:231], v251 offset:512
  ds_read_b64_tr_b16 v[232:233], v250 offset:8192
  ds_read_b64_tr_b16 v[234:235], v250 offset:8704
  ds_read_b64_tr_b16 v[236:237], v251 offset:8192
  ds_read_b64_tr_b16 v[238:239], v251 offset:8704
  ds_read_b64_tr_b16 v[240:241], v250 offset:16384
  ds_read_b64_tr_b16 v[242:243], v250 offset:16896
  s_branch L_gemm_eA
L_gemm_A:
  ds_read_b128 v[192:195], v248 offset:16384
  v_mfma_f32_16x16x32_bf16 v[144:147], v[224:227], v[216:219], v[144:147]
  ds_read_b128 v[196:199], v248 offset:18432
  v_mfma_f32_16x16x32_bf16 v[168:171], v[224:227], v[220:223], v[168:171]
  ds_read_b64_tr_b16 v[224:225], v250 offset:0
  v_mfma_f32_16x16x32_bf16 v[172:175], v[228:231], v[220:223], v[172:175]
  ds_read_b64_tr_b16 v[226:227], v250 offset:512
  v_mfma_f32_16x16x32_bf16 v[148:151], v[228:231], v[216:219], v[148:151]
  ds_read_b128 v[200:203], v248 offset:20480
  v_mfma_f32_16x16x32_bf16 v[124:127], v[228:231], v[212:215], v[124:127]
  ds_read_b128 v[204:207], v248 offset:22528
  v_mfma_f32_16x16x32_bf16 v[100:103], v[228:231], v[208:211], v[100:103]
  ds_read_b64_tr_b16 v[228:229], v251 offset:0
  v_mfma_f32_16x16x32_bf16 v[104:107], v[208:211], v[232:235], v[104:107]
  ds_read_b64_tr_b16 v[230:231], v251 offset:512
  v_mfma_f32_16x16x32_bf16 v[128:131], v[212:215], v[232:235], v[128:131]
  v_mfma_f32_16x16x32_bf16 v[152:155], v[216:219], v[232:235], v[152:155]
  v_mfma_f32_16x16x32_bf16 v[176:179], v[220:223], v[232:235], v[176:179]
  ds_read_b64_tr_b16 v[232:233], v250 offset:8192
  v_mfma_f32_16x16x32_bf16 v[180:183], v[220:223], v[236:239], v[180:183]
  ds_read_b64_tr_b16 v[234:235], v250 offset:8704
  v_mfma_f32_16x16x32_bf16 v[156:159], v[216:219], v[236:239], v[156:159]
  v_mfma_f32_16x16x32_bf16 v[132:135], v[212:215], v[236:239], v[132:135]
  v_mfma_f32_16x16x32_bf16 v[108:111], v[208:211], v[236:239], v[108:111]
  ds_read_b64_tr_b16 v[236:237], v251 offset:8192
  v_mfma_f32_16x16x32_bf16 v[112:115], v[208:211], v[240:243], v[112:115]
  ds_read_b64_tr_b16 v[238:239], v251 offset:8704
  v_mfma_f32_16x16x32_bf16 v[136:139], v[212:215], v[240:243], v[136:139]
  v_mfma_f32_16x16x32_bf16 v[160:163], v[216:219], v[240:243], v[160:163]
  v_mfma_f32_16x16x32_bf16 v[184:187], v[220:223], v[240:243], v[184:187]
  ds_read_b64_tr_b16 v[240:241], v250 offset:16384
  v_mfma_f32_16x16x32_bf16 v[188:191], v[220:223], v[244:247], v[188:191]
  ds_read_b64_tr_b16 v[242:243], v250 offset:16896
  v_mfma_f32_16x16x32_bf16 v[164:167], v[216:219], v[244:247], v[164:167]
  v_mfma_f32_16x16x32_bf16 v[140:143], v[212:215], v[244:247], v[140:143]
  v_mfma_f32_16x16x32_bf16 v[116:119], v[208:211], v[244:247], v[116:119]
L_gemm_eA:
  s_waitcnt lgkmcnt(10)
  v_mfma_f32_16x16x32_bf16 v[0:3], v[224:227], v[192:195], v[0:3]
  ds_read_b64_tr_b16 v[244:245], v251 offset:16384
  v_mfma_f32_16x16x32_bf16 v[24:27], v[224:227], v[196:199], v[24:27]
  ds_read_b64_tr_b16 v[246:247], v251 offset:16896
  s_waitcnt lgkmcnt(11)
  v_mfma_f32_16x16x32_bf16 v[48:51], v[224:227], v[200:203], v[48:51]
  ds_read_b128 v[208:211], v248 offset:0
  s_waitcnt lgkmcnt(11)
  v_mfma_f32_16x16x32_bf16 v[72:75], v[224:227], v[204:207], v[72:75]
  s_waitcnt lgkmcnt(9)
  v_mfma_f32_16x16x32_bf16 v[76:79], v[228:231], v[204:207], v[76:79]
  ds_read_b128 v[212:215], v248 offset:2048
  v_mfma_f32_16x16x32_bf16 v[52:55], v[228:231], v[200:203], v[52:55]
  v_mfma_f32_16x16x32_bf16 v[28:31], v[228:231], v[196:199], v[28:31]
  ds_read_b128 v[216:219], v248 offset:4096
  v_mfma_f32_16x16x32_bf16 v[4:7], v[228:231], v[192:195], v[4:7]
  s_waitcnt lgkmcnt(9)
  v_mfma_f32_16x16x32_bf16 v[8:11], v[192:195], v[232:235], v[8:11]
  ds_read_b128 v[220:223], v248 offset:6144
  v_mfma_f32_16x16x32_bf16 v[32:35], v[196:199], v[232:235], v[32:35]
  v_mfma_f32_16x16x32_bf16 v[56:59], v[200:203], v[232:235], v[56:59]
  s_add_u32 s51, s51, 1
  v_mfma_f32_16x16x32_bf16 v[80:83], v[204:207], v[232:235], v[80:83]
  s_cmp_eq_u32 s51, 3
  s_waitcnt lgkmcnt(8)
  v_mfma_f32_16x16x32_bf16 v[84:87], v[204:207], v[236:239], v[84:87]
  s_cselect_b32 s52, 4294901760, s53
  v_mfma_f32_16x16x32_bf16 v[60:63], v[200:203], v[236:239], v[60:63]
  s_cselect_b32 s51, 0, s51
  v_mfma_f32_16x16x32_bf16 v[36:39], v[196:199], v[236:239], v[36:39]
  v_mfma_f32_16x16x32_bf16 v[12:15], v[192:195], v[236:239], v[12:15]
  s_waitcnt lgkmcnt(6)
  v_mfma_f32_16x16x32_bf16 v[16:19], v[192:195], v[240:243], v[16:19]
  v_add_u32 v248, s52, v248
  v_mfma_f32_16x16x32_bf16 v[40:43], v[196:199], v[240:243], v[40:43]
  v_mfma_f32_16x16x32_bf16 v[64:67], v[200:203], v[240:243], v[64:67]
  v_mfma_f32_16x16x32_bf16 v[88:91], v[204:207], v[240:243], v[88:91]
  s_waitcnt lgkmcnt(4)
  v_mfma_f32_16x16x32_bf16 v[92:95], v[204:207], v[244:247], v[92:95]
  v_mfma_f32_16x16x32_bf16 v[68:71], v[200:203], v[244:247], v[68:71]
  v_mfma_f32_16x16x32_bf16 v[44:47], v[196:199], v[244:247], v[44:47]
  v_mfma_f32_16x16x32_bf16 v[20:23], v[192:195], v[244:247], v[20:23]
  s_waitcnt lgkmcnt(3)
  v_mfma_f32_16x16x32_bf16 v[96:99], v[224:227], v[208:211], v[96:99]
  ds_read_b128 v[192:195], v249 offset:16384
  s_waitcnt lgkmcnt(3)
  v_mfma_f32_16x16x32_bf16 v[120:123], v[224:227], v[212:215], v[120:123]
  ds_read_b128 v[196:199], v249 offset:18432
  s_waitcnt lgkmcnt(3)
  v_mfma_f32_16x16x32_bf16 v[144:147], v[224:227], v[216:219], v[144:147]
  s_waitcnt lgkmcnt(2)
  v_mfma_f32_16x16x32_bf16 v[168:171], v[224:227], v[220:223], v[168:171]
  ds_read_b64_tr_b16 v[224:225], v250 offset:4096
  v_mfma_f32_16x16x32_bf16 v[172:175], v[228:231], v[220:223], v[172:175]
  ds_read_b64_tr_b16 v[226:227], v250 offset:4608
  v_mfma_f32_16x16x32_bf16 v[148:151], v[228:231], v[216:219], v[148:151]
  ds_read_b128 v[200:203], v249 offset:20480
  v_mfma_f32_16x16x32_bf16 v[124:127], v[228:231], v[212:215], v[124:127]
  ds_read_b128 v[204:207], v249 offset:22528
  v_mfma_f32_16x16x32_bf16 v[100:103], v[228:231], v[208:211], v[100:103]
  ds_read_b64_tr_b16 v[228:229], v251 offset:4096
  v_mfma_f32_16x16x32_bf16 v[104:107], v[208:211], v[232:235], v[104:107]
  ds_read_b64_tr_b16 v[230:231], v251 offset:4608
  v_mfma_f32_16x16x32_bf16 v[128:131], v[212:215], v[232:235], v[128:131]
  v_mfma_f32_16x16x32_bf16 v[152:155], v[216:219], v[232:235], v[152:155]
  v_mfma_f32_16x16x32_bf16 v[176:179], v[220:223], v[232:235], v[176:179]
  ds_read_b64_tr_b16 v[232:233], v250 offset:12288
  v_mfma_f32_16x16x32_bf16 v[180:183], v[220:223], v[236:239], v[180:183]
  ds_read_b64_tr_b16 v[234:235], v250 offset:12800
  v_mfma_f32_16x16x32_bf16 v[156:159], v[216:219], v[236:239], v[156:159]
  v_mfma_f32_16x16x32_bf16 v[132:135], v[212:215], v[236:239], v[132:135]
  v_mfma_f32_16x16x32_bf16 v[108:111], v[208:211], v[236:239], v[108:111]
  ds_read_b64_tr_b16 v[236:237], v251 offset:12288
  v_mfma_f32_16x16x32_bf16 v[112:115], v[208:211], v[240:243], v[112:115]
  ds_read_b64_tr_b16 v[238:239], v251 offset:12800
  v_mfma_f32_16x16x32_bf16 v[136:139], v[212:215], v[240:243], v[136:139]
  v_mfma_f32_16x16x32_bf16 v[160:163], v[216:219], v[240:243], v[160:163]
  v_mfma_f32_16x16x32_bf16 v[184:187], v[220:223], v[240:243], v[184:187]
  ds_read_b64_tr_b16 v[240:241], v250 offset:20480
  v_mfma_f32_16x16x32_bf16 v[188:191], v[220:223], v[244:247], v[188:191]
  ds_read_b64_tr_b16 v[242:243], v250 offset:20992
  v_mfma_f32_16x16x32_bf16 v[164:167], v[216:219], v[244:247], v[164:167]
  v_mfma_f32_16x16x32_bf16 v[140:143], v[212:215], v[244:247], v[140:143]
  v_mfma_f32_16x16x32_bf16 v[116:119], v[208:211], v[244:247], v[116:119]
  s_waitcnt lgkmcnt(10)
  v_mfma_f32_16x16x32_bf16 v[0:3], v[224:227], v[192:195], v[0:3]
  ds_read_b64_tr_b16 v[244:245], v251 offset:20480
  v_mfma_f32_16x16x32_bf16 v[24:27], v[224:227], v[196:199], v[24:27]
  ds_read_b64_tr_b16 v[246:247], v251 offset:20992
  s_waitcnt lgkmcnt(11)
  v_mfma_f32_16x16x32_bf16 v[48:51], v[224:227], v[200:203], v[48:51]
  ds_read_b128 v[208:211], v249 offset:0
  s_waitcnt lgkmcnt(11)
  v_mfma_f32_16x16x32_bf16 v[72:75], v[224:227], v[204:207], v[72:75]
  s_waitcnt lgkmcnt(9)
  v_mfma_f32_16x16x32_bf16 v[76:79], v[228:231], v[204:207], v[76:79]
  ds_read_b128 v[212:215], v249 offset:2048
  v_mfma_f32_16x16x32_bf16 v[52:55], v[228:231], v[200:203], v[52:55]
  v_mfma_f32_16x16x32_bf16 v[28:31], v[228:231], v[196:199], v[28:31]
  ds_read_b128 v[216:219], v249 offset:4096
  v_mfma_f32_16x16x32_bf16 v[4:7], v[228:231], v[192:195], v[4:7]
  s_waitcnt lgkmcnt(9)
  v_mfma_f32_16x16x32_bf16 v[8:11], v[192:195], v[232:235], v[8:11]
  ds_read_b128 v[220:223], v249 offset:6144
  v_mfma_f32_16x16x32_bf16 v[32:35], v[196:199], v[232:235], v[32:35]
  v_mfma_f32_16x16x32_bf16 v[56:59], v[200:203], v[232:235], v[56:59]
  v_mfma_f32_16x16x32_bf16 v[80:83], v[204:207], v[232:235], v[80:83]
  s_waitcnt lgkmcnt(8)
  v_mfma_f32_16x16x32_bf16 v[84:87], v[204:207], v[236:239], v[84:87]
  v_mfma_f32_16x16x32_bf16 v[60:63], v[200:203], v[236:239], v[60:63]
  v_mfma_f32_16x16x32_bf16 v[36:39], v[196:199], v[236:239], v[36:39]
  v_mfma_f32_16x16x32_bf16 v[12:15], v[192:195], v[236:239], v[12:15]
  s_waitcnt lgkmcnt(6)
  v_mfma_f32_16x16x32_bf16 v[16:19], v[192:195], v[240:243], v[16:19]
  v_add_u32 v249, s52, v249
  v_mfma_f32_16x16x32_bf16 v[40:43], v[196:199], v[240:243], v[40:43]
  v_mfma_f32_16x16x32_bf16 v[64:67], v[200:203], v[240:243], v[64:67]
  v_mfma_f32_16x16x32_bf16 v[88:91], v[204:207], v[240:243], v[88:91]
  s_waitcnt lgkmcnt(4)
  v_mfma_f32_16x16x32_bf16 v[92:95], v[204:207], v[244:247], v[92:95]
  v_mfma_f32_16x16x32_bf16 v[68:71], v[200:203], v[244:247], v[68:71]
  v_mfma_f32_16x16x32_bf16 v[44:47], v[196:199], v[244:247], v[44:47]
  v_mfma_f32_16x16x32_bf16 v[20:23], v[192:195], v[244:247], v[20:23]
  s_waitcnt lgkmcnt(3)
  v_mfma_f32_16x16x32_bf16 v[96:99], v[224:227], v[208:211], v[96:99]
  s_waitcnt lgkmcnt(0)
  s_barrier
  v_mfma_f32_16x16x32_bf16 v[120:123], v[224:227], v[212:215], v[120:123]
  ds_read_b128 v[192:195], v248 offset:16384
  v_mfma_f32_16x16x32_bf16 v[144:147], v[224:227], v[216:219], v[144:147]
  ds_read_b128 v[196:199], v248 offset:18432
  v_mfma_f32_16x16x32_bf16 v[168:171], v[224:227], v[220:223], v[168:171]
  ds_read_b64_tr_b16 v[224:225], v250 offset:24576
  v_mfma_f32_16x16x32_bf16 v[172:175], v[228:231], v[220:223], v[172:175]
  ds_read_b64_tr_b16 v[226:227], v250 offset:25088
  v_mfma_f32_16x16x32_bf16 v[148:151], v[228:231], v[216:219], v[148:151]
  ds_read_b128 v[200:203], v248 offset:20480
  v_mfma_f32_16x16x32_bf16 v[124:127], v[228:231], v[212:215], v[124:127]
  ds_read_b128 v[204:207], v248 offset:22528
  v_mfma_f32_16x16x32_bf16 v[100:103], v[228:231], v[208:211], v[100:103]
  ds_read_b64_tr_b16 v[228:229], v251 offset:24576
  v_mfma_f32_16x16x32_bf16 v[104:107], v[208:211], v[232:235], v[104:107]
  ds_read_b64_tr_b16 v[230:231], v251 offset:25088
  v_mfma_f32_16x16x32_bf16 v[128:131], v[212:215], v[232:235], v[128:131]
  v_mfma_f32_16x16x32_bf16 v[152:155], v[216:219], v[232:235], v[152:155]
  v_mfma_f32_16x16x32_bf16 v[176:179], v[220:223], v[232:235], v[176:179]
  ds_read_b64_tr_b16 v[232:233], v250 offset:32768
  v_mfma_f32_16x16x32_bf16 v[180:183], v[220:223], v[236:239], v[180:183]
  ds_read_b64_tr_b16 v[234:235], v250 offset:33280
  v_mfma_f32_16x16x32_bf16 v[156:159], v[216:219], v[236:239], v[156:159]
  v_mfma_f32_16x16x32_bf16 v[132:135], v[212:215], v[236:239], v[132:135]
  v_mfma_f32_16x16x32_bf16 v[108:111], v[208:211], v[236:239], v[108:111]
  ds_read_b64_tr_b16 v[236:237], v251 offset:32768
  v_mfma_f32_16x16x32_bf16 v[112:115], v[208:211], v[240:243], v[112:115]
  ds_read_b64_tr_b16 v[238:239], v251 offset:33280
  v_mfma_f32_16x16x32_bf16 v[136:139], v[212:215], v[240:243], v[136:139]
  v_mfma_f32_16x16x32_bf16 v[160:163], v[216:219], v[240:243], v[160:163]
  v_mfma_f32_16x16x32_bf16 v[184:187], v[220:223], v[240:243], v[184:187]
  ds_read_b64_tr_b16 v[240:241], v250 offset:40960
  v_mfma_f32_16x16x32_bf16 v[188:191], v[220:223], v[244:247], v[188:191]
  ds_read_b64_tr_b16 v[242:243], v250 offset:41472
  v_mfma_f32_16x16x32_bf16 v[164:167], v[216:219], v[244:247], v[164:167]
  v_mfma_f32_16x16x32_bf16 v[140:143], v[212:215], v[244:247], v[140:143]
  v_mfma_f32_16x16x32_bf16 v[116:119], v[208:211], v[244:247], v[116:119]
  s_waitcnt lgkmcnt(10)
  v_mfma_f32_16x16x32_bf16 v[0:3], v[224:227], v[192:195], v[0:3]
  ds_read_b64_tr_b16 v[244:245], v251 offset:40960
  v_mfma_f32_16x16x32_bf16 v[24:27], v[224:227], v[196:199], v[24:27]
  ds_read_b64_tr_b16 v[246:247], v251 offset:41472
  s_waitcnt lgkmcnt(11)
  v_mfma_f32_16x16x32_bf16 v[48:51], v[224:227], v[200:203], v[48:51]
  ds_read_b128 v[208:211], v248 offset:0
  s_waitcnt lgkmcnt(11)
  v_mfma_f32_16x16x32_bf16 v[72:75], v[224:227], v[204:207], v[72:75]
  s_waitcnt lgkmcnt(9)
  v_mfma_f32_16x16x32_bf16 v[76:79], v[228:231], v[204:207], v[76:79]
  ds_read_b128 v[212:215], v248 offset:2048
  v_mfma_f32_16x16x32_bf16 v[52:55], v[228:231], v[200:203], v[52:55]
  v_mfma_f32_16x16x32_bf16 v[28:31], v[228:231], v[196:199], v[28:31]
  ds_read_b128 v[216:219], v248 offset:4096
  v_mfma_f32_16x16x32_bf16 v[4:7], v[228:231], v[192:195], v[4:7]
  s_waitcnt lgkmcnt(9)
  v_mfma_f32_16x16x32_bf16 v[8:11], v[192:195], v[232:235], v[8:11]
  ds_read_b128 v[220:223], v248 offset:6144
  v_mfma_f32_16x16x32_bf16 v[32:35], v[196:199], v[232:235], v[32:35]
  v_mfma_f32_16x16x32_bf16 v[56:59], v[200:203], v[232:235], v[56:59]
  s_add_u32 s51, s51, 1
  v_mfma_f32_16x16x32_bf16 v[80:83], v[204:207], v[232:235], v[80:83]
  s_cmp_eq_u32 s51, 3
  s_waitcnt lgkmcnt(8)
  v_mfma_f32_16x16x32_bf16 v[84:87], v[204:207], v[236:239], v[84:87]
  s_cselect_b32 s52, 4294901760, s53
  v_mfma_f32_16x16x32_bf16 v[60:63], v[200:203], v[236:239], v[60:63]
  s_cselect_b32 s51, 0, s51
  v_mfma_f32_16x16x32_bf16 v[36:39], v[196:199], v[236:239], v[36:39]
  v_mfma_f32_16x16x32_bf16 v[12:15], v[192:195], v[236:239], v[12:15]
  s_waitcnt lgkmcnt(6)
  v_mfma_f32_16x16x32_bf16 v[16:19], v[192:195], v[240:243], v[16:19]
  v_add_u32 v248, s52, v248
  v_mfma_f32_16x16x32_bf16 v[40:43], v[196:199], v[240:243], v[40:43]
  v_mfma_f32_16x16x32_bf16 v[64:67], v[200:203], v[240:243], v[64:67]
  v_mfma_f32_16x16x32_bf16 v[88:91], v[204:207], v[240:243], v[88:91]
  s_waitcnt lgkmcnt(4)
  v_mfma_f32_16x16x32_bf16 v[92:95], v[204:207], v[244:247], v[92:95]
  v_mfma_f32_16x16x32_bf16 v[68:71], v[200:203], v[244:247], v[68:71]
  v_mfma_f32_16x16x32_bf16 v[44:47], v[196:199], v[244:247], v[44:47]
  v_mfma_f32_16x16x32_bf16 v[20:23], v[192:195], v[244:247], v[20:23]
  s_waitcnt lgkmcnt(3)
  v_mfma_f32_16x16x32_bf16 v[96:99], v[224:227], v[208:211], v[96:99]
  ds_read_b128 v[192:195], v249 offset:16384
  s_waitcnt lgkmcnt(3)
  v_mfma_f32_16x16x32_bf16 v[120:123], v[224:227], v[212:215], v[120:123]
  ds_read_b128 v[196:199], v249 offset:18432
  s_waitcnt lgkmcnt(3)
  v_mfma_f32_16x16x32_bf16 v[144:147], v[224:227], v[216:219], v[144:147]
  s_waitcnt lgkmcnt(2)
  v_mfma_f32_16x16x32_bf16 v[168:171], v[224:227], v[220:223], v[168:171]
  ds_read_b64_tr_b16 v[224:225], v250 offset:28672
  v_mfma_f32_16x16x32_bf16 v[172:175], v[228:231], v[220:223], v[172:175]
  ds_read_b64_tr_b16 v[226:227], v250 offset:29184
  v_mfma_f32_16x16x32_bf16 v[148:151], v[228:231], v[216:219], v[148:151]
  ds_read_b128 v[200:203], v249 offset:20480
  v_mfma_f32_16x16x32_bf16 v[124:127], v[228:231], v[212:215], v[124:127]
  ds_read_b128 v[204:207], v249 offset:22528
  v_mfma_f32_16x16x32_bf16 v[100:103], v[228:231], v[208:211], v[100:103]
  ds_read_b64_tr_b16 v[228:229], v251 offset:28672
  v_mfma_f32_16x16x32_bf16 v[104:107], v[208:211], v[232:235], v[104:107]
  ds_read_b64_tr_b16 v[230:231], v251 offset:29184
  v_mfma_f32_16x16x32_bf16 v[128:131], v[212:215], v[232:235], v[128:131]
  v_mfma_f32_16x16x32_bf16 v[152:155], v[216:219], v[232:235], v[152:155]
  v_mfma_f32_16x16x32_bf16 v[176:179], v[220:223], v[232:235], v[176:179]
  ds_read_b64_tr_b16 v[232:233], v250 offset:36864
  v_mfma_f32_16x16x32_bf16 v[180:183], v[220:223], v[236:239], v[180:183]
  ds_read_b64_tr_b16 v[234:235], v250 offset:37376
  v_mfma_f32_16x16x32_bf16 v[156:159], v[216:219], v[236:239], v[156:159]
  v_mfma_f32_16x16x32_bf16 v[132:135], v[212:215], v[236:239], v[132:135]
  v_mfma_f32_16x16x32_bf16 v[108:111], v[208:211], v[236:239], v[108:111]
  ds_read_b64_tr_b16 v[236:237], v251 offset:36864
  v_mfma_f32_16x16x32_bf16 v[112:115], v[208:211], v[240:243], v[112:115]
  ds_read_b64_tr_b16 v[238:239], v251 offset:37376
  v_mfma_f32_16x16x32_bf16 v[136:139], v[212:215], v[240:243], v[136:139]
  v_mfma_f32_16x16x32_bf16 v[160:163], v[216:219], v[240:243], v[160:163]
  v_mfma_f32_16x16x32_bf16 v[184:187], v[220:223], v[240:243], v[184:187]
  ds_read_b64_tr_b16 v[240:241], v250 offset:45056
  v_mfma_f32_16x16x32_bf16 v[188:191], v[220:223], v[244:247], v[188:191]
  ds_read_b64_tr_b16 v[242:243], v250 offset:45568
  v_mfma_f32_16x16x32_bf16 v[164:167], v[216:219], v[244:247], v[164:167]
  v_mfma_f32_16x16x32_bf16 v[140:143], v[212:215], v[244:247], v[140:143]
  v_mfma_f32_16x16x32_bf16 v[116:119], v[208:211], v[244:247], v[116:119]
  s_waitcnt lgkmcnt(10)
  v_mfma_f32_16x16x32_bf16 v[0:3], v[224:227], v[192:195], v[0:3]
  ds_read_b64_tr_b16 v[244:245], v251 offset:45056
  v_mfma_f32_16x16x32_bf16 v[24:27], v[224:227], v[196:199], v[24:27]
  ds_read_b64_tr_b16 v[246:247], v251 offset:45568
  s_waitcnt lgkmcnt(11)
  v_mfma_f32_16x16x32_bf16 v[48:51], v[224:227], v[200:203], v[48:51]
  ds_read_b128 v[208:211], v249 offset:0
  s_waitcnt lgkmcnt(11)
  v_mfma_f32_16x16x32_bf16 v[72:75], v[224:227], v[204:207], v[72:75]
  s_waitcnt lgkmcnt(9)
  v_mfma_f32_16x16x32_bf16 v[76:79], v[228:231], v[204:207], v[76:79]
  ds_read_b128 v[212:215], v249 offset:2048
  v_mfma_f32_16x16x32_bf16 v[52:55], v[228:231], v[200:203], v[52:55]
  v_mfma_f32_16x16x32_bf16 v[28:31], v[228:231], v[196:199], v[28:31]
  ds_read_b128 v[216:219], v249 offset:4096
  v_mfma_f32_16x16x32_bf16 v[4:7], v[228:231], v[192:195], v[4:7]
  s_waitcnt lgkmcnt(9)
  v_mfma_f32_16x16x32_bf16 v[8:11], v[192:195], v[232:235], v[8:11]
  ds_read_b128 v[220:223], v249 offset:6144
  v_mfma_f32_16x16x32_bf16 v[32:35], v[196:199], v[232:235], v[32:35]
  v_mfma_f32_16x16x32_bf16 v[56:59], v[200:203], v[232:235], v[56:59]
  v_mfma_f32_16x16x32_bf16 v[80:83], v[204:207], v[232:235], v[80:83]
  s_waitcnt lgkmcnt(8)
  v_mfma_f32_16x16x32_bf16 v[84:87], v[204:207], v[236:239], v[84:87]
  v_mfma_f32_16x16x32_bf16 v[60:63], v[200:203], v[236:239], v[60:63]
  v_mfma_f32_16x16x32_bf16 v[36:39], v[196:199], v[236:239], v[36:39]
  v_mfma_f32_16x16x32_bf16 v[12:15], v[192:195], v[236:239], v[12:15]
  s_waitcnt lgkmcnt(6)
  v_mfma_f32_16x16x32_bf16 v[16:19], v[192:195], v[240:243], v[16:19]
  v_add_u32 v249, s52, v249
  v_mfma_f32_16x16x32_bf16 v[40:43], v[196:199], v[240:243], v[40:43]
  v_mfma_f32_16x16x32_bf16 v[64:67], v[200:203], v[240:243], v[64:67]
  s_sub_u32 s50, s50, 1
  v_mfma_f32_16x16x32_bf16 v[88:91], v[204:207], v[240:243], v[88:91]
  s_waitcnt lgkmcnt(4)
  v_mfma_f32_16x16x32_bf16 v[92:95], v[204:207], v[244:247], v[92:95]
  v_mfma_f32_16x16x32_bf16 v[68:71], v[200:203], v[244:247], v[68:71]
  s_cmp_lg_u32 s50, 0
  v_mfma_f32_16x16x32_bf16 v[44:47], v[196:199], v[244:247], v[44:47]
  v_mfma_f32_16x16x32_bf16 v[20:23], v[192:195], v[244:247], v[20:23]
  s_waitcnt lgkmcnt(3)
  v_mfma_f32_16x16x32_bf16 v[96:99], v[224:227], v[208:211], v[96:99]
  s_waitcnt lgkmcnt(0)
  s_barrier
  v_mfma_f32_16x16x32_bf16 v[120:123], v[224:227], v[212:215], v[120:123]
  s_cbranch_scc1 L_gemm_A
  v_mfma_f32_16x16x32_bf16 v[104:107], v[208:211], v[232:235], v[104:107]
  s_mov_b32 s64, 0x3fb8aa3b
  s_mov_b32 s66, 0x358637bd
  s_mul_i32 s46, s40, 6144
  v_lshlrev_b32 v253, 4, v252
  v_mfma_f32_16x16x32_bf16 v[128:131], v[212:215], v[232:235], v[128:131]
  v_add_u32 v248, s46, v253
  s_and_b32 s47, s40, 1
  s_mul_i32 s46, s47, 3072
  s_add_u32 s46, s46, 32768
  v_mfma_f32_16x16x32_bf16 v[152:155], v[216:219], v[232:235], v[152:155]
  v_add_u32 v249, s46, v253
  .p2align 3
  v_pk_fma_f32 v[192:193], v[8:9], s[64:65], s[64:65] op_sel_hi:[1,0,0] neg_lo:[0,0,1] neg_hi:[0,0,1]
  v_pk_fma_f32 v[194:195], v[10:11], s[64:65], s[64:65] op_sel_hi:[1,0,0] neg_lo:[0,0,1] neg_hi:[0,0,1]
  v_mfma_f32_16x16x32_bf16 v[176:179], v[220:223], v[232:235], v[176:179]
  v_pk_fma_f32 v[196:197], v[32:33], s[64:65], s[64:65] op_sel_hi:[1,0,0] neg_lo:[0,0,1] neg_hi:[0,0,1]
  v_pk_fma_f32 v[198:199], v[34:35], s[64:65], s[64:65] op_sel_hi:[1,0,0] neg_lo:[0,0,1] neg_hi:[0,0,1]
  v_exp_f32_e64 v192, v192 clamp
  v_exp_f32_e64 v193, v193 clamp
  v_mfma_f32_16x16x32_bf16 v[180:183], v[220:223], v[236:239], v[180:183]
  v_exp_f32_e64 v194, v194 clamp
  v_exp_f32_e64 v195, v195 clamp
  v_exp_f32_e64 v196, v196 clamp
  v_exp_f32_e64 v197, v197 clamp
  v_mfma_f32_16x16x32_bf16 v[156:159], v[216:219], v[236:239], v[156:159]
  v_exp_f32_e64 v198, v198 clamp
  v_exp_f32_e64 v199, v199 clamp
  v_max_f32 v192, v192, v8
  v_max_f32 v193, v193, v9
  v_mfma_f32_16x16x32_bf16 v[132:135], v[212:215], v[236:239], v[132:135]
  v_max_f32 v194, v194, v10
  v_max_f32 v195, v195, v11
  v_max_f32 v196, v196, v32
  v_max_f32 v197, v197, v33
  v_mfma_f32_16x16x32_bf16 v[108:111], v[208:211], v[236:239], v[108:111]
  v_max_f32 v198, v198, v34
  v_max_f32 v199, v199, v35
  v_pk_add_f32 v[192:193], v[192:193], s[66:67] op_sel_hi:[1,0]
  v_pk_add_f32 v[194:195], v[194:195], s[66:67] op_sel_hi:[1,0]
  v_mfma_f32_16x16x32_bf16 v[112:115], v[208:211], v[240:243], v[112:115]
  v_pk_add_f32 v[196:197], v[196:197], s[66:67] op_sel_hi:[1,0]
  v_pk_add_f32 v[198:199], v[198:199], s[66:67] op_sel_hi:[1,0]
  v_cvt_pk_bf16_f32 v8, v192, v193
  v_cvt_pk_bf16_f32 v9, v194, v195
  v_mfma_f32_16x16x32_bf16 v[136:139], v[212:215], v[240:243], v[136:139]
  v_cvt_pk_bf16_f32 v10, v196, v197
  v_cvt_pk_bf16_f32 v11, v198, v199
  v_pk_fma_f32 v[192:193], v[12:13], s[64:65], s[64:65] op_sel_hi:[1,0,0] neg_lo:[0,0,1] neg_hi:[0,0,1]
  v_pk_fma_f32 v[194:195], v[14:15], s[64:65], s[64:65] op_sel_hi:[1,0,0] neg_lo:[0,0,1] neg_hi:[0,0,1]
  v_mfma_f32_16x16x32_bf16 v[160:163], v[216:219], v[240:243], v[160:163]
  v_pk_fma_f32 v[196:197], v[36:37], s[64:65], s[64:65] op_sel_hi:[1,0,0] neg_lo:[0,0,1] neg_hi:[0,0,1]
  v_pk_fma_f32 v[198:199], v[38:39], s[64:65], s[64:65] op_sel_hi:[1,0,0] neg_lo:[0,0,1] neg_hi:[0,0,1]
  v_exp_f32_e64 v192, v192 clamp
  v_exp_f32_e64 v193, v193 clamp
  v_mfma_f32_16x16x32_bf16 v[184:187], v[220:223], v[240:243], v[184:187]
  v_exp_f32_e64 v194, v194 clamp
  v_exp_f32_e64 v195, v195 clamp
  v_exp_f32_e64 v196, v196 clamp
  v_exp_f32_e64 v197, v197 clamp
  v_mfma_f32_16x16x32_bf16 v[188:191], v[220:223], v[244:247], v[188:191]
  v_exp_f32_e64 v198, v198 clamp
  v_exp_f32_e64 v199, v199 clamp
  v_max_f32 v192, v192, v12
  v_max_f32 v193, v193, v13
  v_mfma_f32_16x16x32_bf16 v[164:167], v[216:219], v[244:247], v[164:167]
  v_max_f32 v194, v194, v14
  v_max_f32 v195, v195, v15
  v_max_f32 v196, v196, v36
  v_max_f32 v197, v197, v37
  v_mfma_f32_16x16x32_bf16 v[140:143], v[212:215], v[244:247], v[140:143]
  v_max_f32 v198, v198, v38
  v_max_f32 v199, v199, v39
  v_pk_add_f32 v[192:193], v[192:193], s[66:67] op_sel_hi:[1,0]
  v_pk_add_f32 v[194:195], v[194:195], s[66:67] op_sel_hi:[1,0]
  v_mfma_f32_16x16x32_bf16 v[116:119], v[208:211], v[244:247], v[116:119]
  v_pk_add_f32 v[196:197], v[196:197], s[66:67] op_sel_hi:[1,0]
  v_pk_add_f32 v[198:199], v[198:199], s[66:67] op_sel_hi:[1,0]
  v_cvt_pk_bf16_f32 v12, v192, v193
  v_cvt_pk_bf16_f32 v13, v194, v195
  v_mfma_f32_16x16x32_bf16 v[144:147], v[224:227], v[216:219], v[144:147]
  v_cvt_pk_bf16_f32 v14, v196, v197
  v_cvt_pk_bf16_f32 v15, v198, v199
  v_cvt_pk_bf16_f32 v16, v16, v17
  v_cvt_pk_bf16_f32 v17, v18, v19
  v_mfma_f32_16x16x32_bf16 v[168:171], v[224:227], v[220:223], v[168:171]
  v_cvt_pk_bf16_f32 v18, v40, v41
  v_cvt_pk_bf16_f32 v19, v42, v43
  v_cvt_pk_bf16_f32 v20, v20, v21
  v_cvt_pk_bf16_f32 v21, v22, v23
  v_mfma_f32_16x16x32_bf16 v[172:175], v[228:231], v[220:223], v[172:175]
  v_cvt_pk_bf16_f32 v22, v44, v45
  v_cvt_pk_bf16_f32 v23, v46, v47
  v_mfma_f32_16x16x32_bf16 v[148:151], v[228:231], v[216:219], v[148:151]
  v_mfma_f32_16x16x32_bf16 v[124:127], v[228:231], v[212:215], v[124:127]
  v_mfma_f32_16x16x32_bf16 v[100:103], v[228:231], v[208:211], v[100:103]
  v_mov_b32 v224, 0x3f803f80
  v_mov_b32 v225, 0x3f803f80
  v_mov_b32 v226, 0x3f803f80
  v_mov_b32 v227, 0x3f803f80
  v_pk_fma_f32 v[216:217], v[56:57], s[64:65], s[64:65] op_sel_hi:[1,0,0] neg_lo:[0,0,1] neg_hi:[0,0,1]
  v_pk_fma_f32 v[218:219], v[58:59], s[64:65], s[64:65] op_sel_hi:[1,0,0] neg_lo:[0,0,1] neg_hi:[0,0,1]
  v_pk_fma_f32 v[220:221], v[80:81], s[64:65], s[64:65] op_sel_hi:[1,0,0] neg_lo:[0,0,1] neg_hi:[0,0,1]
  v_mfma_f32_16x16x32_bf16 v[200:203], v[8:11], v[224:227], 0
  v_pk_fma_f32 v[222:223], v[82:83], s[64:65], s[64:65] op_sel_hi:[1,0,0] neg_lo:[0,0,1] neg_hi:[0,0,1]
  v_exp_f32_e64 v216, v216 clamp
  v_exp_f32_e64 v217, v217 clamp
  v_mfma_f32_16x16x32_bf16 v[212:215], v[12:15], v[224:227], 0
  v_exp_f32_e64 v218, v218 clamp
  v_exp_f32_e64 v219, v219 clamp
  v_exp_f32_e64 v220, v220 clamp
  v_mfma_f32_16x16x32_bf16 v[192:195], v[8:11], v[16:19], 0
  v_exp_f32_e64 v221, v221 clamp
  v_exp_f32_e64 v222, v222 clamp
  v_exp_f32_e64 v223, v223 clamp
  v_mfma_f32_16x16x32_bf16 v[196:199], v[12:15], v[16:19], 0
  v_max_f32 v216, v216, v56
  v_max_f32 v217, v217, v57
  v_max_f32 v218, v218, v58
  v_mfma_f32_16x16x32_bf16 v[204:207], v[8:11], v[20:23], 0
  v_max_f32 v219, v219, v59
  v_max_f32 v220, v220, v80
  v_max_f32 v221, v221, v81
  v_mfma_f32_16x16x32_bf16 v[208:211], v[12:15], v[20:23], 0
  v_max_f32 v222, v222, v82
  v_max_f32 v223, v223, v83
  v_pk_add_f32 v[216:217], v[216:217], s[66:67] op_sel_hi:[1,0]
  v_pk_add_f32 v[218:219], v[218:219], s[66:67] op_sel_hi:[1,0]
  v_pk_add_f32 v[220:221], v[220:221], s[66:67] op_sel_hi:[1,0]
  v_pk_add_f32 v[222:223], v[222:223], s[66:67] op_sel_hi:[1,0]
  v_cvt_pk_bf16_f32 v56, v216, v217
  v_cvt_pk_bf16_f32 v57, v218, v219
  v_cvt_pk_bf16_f32 v58, v220, v221
  v_cvt_pk_bf16_f32 v59, v222, v223
  v_pk_fma_f32 v[216:217], v[60:61], s[64:65], s[64:65] op_sel_hi:[1,0,0] neg_lo:[0,0,1] neg_hi:[0,0,1]
  v_pk_fma_f32 v[218:219], v[62:63], s[64:65], s[64:65] op_sel_hi:[1,0,0] neg_lo:[0,0,1] neg_hi:[0,0,1]
  v_pk_fma_f32 v[220:221], v[84:85], s[64:65], s[64:65] op_sel_hi:[1,0,0] neg_lo:[0,0,1] neg_hi:[0,0,1]
  v_pk_fma_f32 v[222:223], v[86:87], s[64:65], s[64:65] op_sel_hi:[1,0,0] neg_lo:[0,0,1] neg_hi:[0,0,1]
  v_exp_f32_e64 v216, v216 clamp
  v_exp_f32_e64 v217, v217 clamp
  v_exp_f32_e64 v218, v218 clamp
  v_exp_f32_e64 v219, v219 clamp
  v_exp_f32_e64 v220, v220 clamp
  v_exp_f32_e64 v221, v221 clamp
  v_exp_f32_e64 v222, v222 clamp
  v_exp_f32_e64 v223, v223 clamp
  v_max_f32 v216, v216, v60
  v_max_f32 v217, v217, v61
  v_max_f32 v218, v218, v62
  v_max_f32 v219, v219, v63
  v_max_f32 v220, v220, v84
  v_max_f32 v221, v221, v85
  v_max_f32 v222, v222, v86
  v_max_f32 v223, v223, v87
  v_pk_add_f32 v[216:217], v[216:217], s[66:67] op_sel_hi:[1,0]
  v_pk_add_f32 v[218:219], v[218:219], s[66:67] op_sel_hi:[1,0]
  v_pk_add_f32 v[220:221], v[220:221], s[66:67] op_sel_hi:[1,0]
  v_pk_add_f32 v[222:223], v[222:223], s[66:67] op_sel_hi:[1,0]
  v_cvt_pk_bf16_f32 v60, v216, v217
  v_cvt_pk_bf16_f32 v61, v218, v219
  v_cvt_pk_bf16_f32 v62, v220, v221
  v_cvt_pk_bf16_f32 v63, v222, v223
  v_cvt_pk_bf16_f32 v64, v64, v65
  v_cvt_pk_bf16_f32 v65, v66, v67
  v_cvt_pk_bf16_f32 v66, v88, v89
  v_cvt_pk_bf16_f32 v67, v90, v91
  v_cvt_pk_bf16_f32 v68, v68, v69
  v_cvt_pk_bf16_f32 v69, v70, v71
  v_cvt_pk_bf16_f32 v70, v92, v93
  v_cvt_pk_bf16_f32 v71, v94, v95
  v_pk_fma_f32 v[216:217], v[104:105], s[64:65], s[64:65] op_sel_hi:[1,0,0] neg_lo:[0,0,1] neg_hi:[0,0,1]
  v_pk_fma_f32 v[218:219], v[106:107], s[64:65], s[64:65] op_sel_hi:[1,0,0] neg_lo:[0,0,1] neg_hi:[0,0,1]
  v_pk_fma_f32 v[220:221], v[128:129], s[64:65], s[64:65] op_sel_hi:[1,0,0] neg_lo:[0,0,1] neg_hi:[0,0,1]
  v_mfma_f32_16x16x32_bf16 v[200:203], v[56:59], v[224:227], v[200:203]
  v_pk_fma_f32 v[222:223], v[130:131], s[64:65], s[64:65] op_sel_hi:[1,0,0] neg_lo:[0,0,1] neg_hi:[0,0,1]
  v_exp_f32_e64 v216, v216 clamp
  v_exp_f32_e64 v217, v217 clamp
  v_mfma_f32_16x16x32_bf16 v[212:215], v[60:63], v[224:227], v[212:215]
  v_exp_f32_e64 v218, v218 clamp
  v_exp_f32_e64 v219, v219 clamp
  v_exp_f32_e64 v220, v220 clamp
  v_mfma_f32_16x16x32_bf16 v[192:195], v[56:59], v[64:67], v[192:195]
  v_exp_f32_e64 v221, v221 clamp
  v_exp_f32_e64 v222, v222 clamp
  v_exp_f32_e64 v223, v223 clamp
  v_mfma_f32_16x16x32_bf16 v[196:199], v[60:63], v[64:67], v[196:199]
  v_max_f32 v216, v216, v104
  v_max_f32 v217, v217, v105
  v_max_f32 v218, v218, v106
  v_mfma_f32_16x16x32_bf16 v[204:207], v[56:59], v[68:71], v[204:207]
  v_max_f32 v219, v219, v107
  v_max_f32 v220, v220, v128
  v_max_f32 v221, v221, v129
  v_mfma_f32_16x16x32_bf16 v[208:211], v[60:63], v[68:71], v[208:211]
  v_max_f32 v222, v222, v130
  v_max_f32 v223, v223, v131
  v_pk_add_f32 v[216:217], v[216:217], s[66:67] op_sel_hi:[1,0]
  v_pk_add_f32 v[218:219], v[218:219], s[66:67] op_sel_hi:[1,0]
  v_pk_add_f32 v[220:221], v[220:221], s[66:67] op_sel_hi:[1,0]
  v_pk_add_f32 v[222:223], v[222:223], s[66:67] op_sel_hi:[1,0]
  v_cvt_pk_bf16_f32 v104, v216, v217
  v_cvt_pk_bf16_f32 v105, v218, v219
  v_cvt_pk_bf16_f32 v106, v220, v221
  v_cvt_pk_bf16_f32 v107, v222, v223
  v_pk_fma_f32 v[216:217], v[108:109], s[64:65], s[64:65] op_sel_hi:[1,0,0] neg_lo:[0,0,1] neg_hi:[0,0,1]
  v_pk_fma_f32 v[218:219], v[110:111], s[64:65], s[64:65] op_sel_hi:[1,0,0] neg_lo:[0,0,1] neg_hi:[0,0,1]
  v_pk_fma_f32 v[220:221], v[132:133], s[64:65], s[64:65] op_sel_hi:[1,0,0] neg_lo:[0,0,1] neg_hi:[0,0,1]
  v_pk_fma_f32 v[222:223], v[134:135], s[64:65], s[64:65] op_sel_hi:[1,0,0] neg_lo:[0,0,1] neg_hi:[0,0,1]
  v_exp_f32_e64 v216, v216 clamp
  v_exp_f32_e64 v217, v217 clamp
  v_exp_f32_e64 v218, v218 clamp
  v_exp_f32_e64 v219, v219 clamp
  v_exp_f32_e64 v220, v220 clamp
  v_exp_f32_e64 v221, v221 clamp
  v_exp_f32_e64 v222, v222 clamp
  v_exp_f32_e64 v223, v223 clamp
  v_max_f32 v216, v216, v108
  v_max_f32 v217, v217, v109
  v_max_f32 v218, v218, v110
  v_max_f32 v219, v219, v111
  v_max_f32 v220, v220, v132
  v_max_f32 v221, v221, v133
  v_max_f32 v222, v222, v134
  v_max_f32 v223, v223, v135
  v_pk_add_f32 v[216:217], v[216:217], s[66:67] op_sel_hi:[1,0]
  v_pk_add_f32 v[218:219], v[218:219], s[66:67] op_sel_hi:[1,0]
  v_pk_add_f32 v[220:221], v[220:221], s[66:67] op_sel_hi:[1,0]
  v_pk_add_f32 v[222:223], v[222:223], s[66:67] op_sel_hi:[1,0]
  v_cvt_pk_bf16_f32 v108, v216, v217
  v_cvt_pk_bf16_f32 v109, v218, v219
  v_cvt_pk_bf16_f32 v110, v220, v221
  v_cvt_pk_bf16_f32 v111, v222, v223
  v_cvt_pk_bf16_f32 v112, v112, v113
  v_cvt_pk_bf16_f32 v113, v114, v115
  v_cvt_pk_bf16_f32 v114, v136, v137
  v_cvt_pk_bf16_f32 v115, v138, v139
  v_cvt_pk_bf16_f32 v116, v116, v117
  v_cvt_pk_bf16_f32 v117, v118, v119
  v_cvt_pk_bf16_f32 v118, v140, v141
  v_cvt_pk_bf16_f32 v119, v142, v143
  v_pk_fma_f32 v[216:217], v[152:153], s[64:65], s[64:65] op_sel_hi:[1,0,0] neg_lo:[0,0,1] neg_hi:[0,0,1]
  v_pk_fma_f32 v[218:219], v[154:155], s[64:65], s[64:65] op_sel_hi:[1,0,0] neg_lo:[0,0,1] neg_hi:[0,0,1]
  v_pk_fma_f32 v[220:221], v[176:177], s[64:65], s[64:65] op_sel_hi:[1,0,0] neg_lo:[0,0,1] neg_hi:[0,0,1]
  v_mfma_f32_16x16x32_bf16 v[200:203], v[104:107], v[224:227], v[200:203]
  v_pk_fma_f32 v[222:223], v[178:179], s[64:65], s[64:65] op_sel_hi:[1,0,0] neg_lo:[0,0,1] neg_hi:[0,0,1]
  v_exp_f32_e64 v216, v216 clamp
  v_exp_f32_e64 v217, v217 clamp
  v_mfma_f32_16x16x32_bf16 v[212:215], v[108:111], v[224:227], v[212:215]
  v_exp_f32_e64 v218, v218 clamp
  v_exp_f32_e64 v219, v219 clamp
  v_exp_f32_e64 v220, v220 clamp
  v_mfma_f32_16x16x32_bf16 v[192:195], v[104:107], v[112:115], v[192:195]
  v_exp_f32_e64 v221, v221 clamp
  v_exp_f32_e64 v222, v222 clamp
  v_exp_f32_e64 v223, v223 clamp
  v_mfma_f32_16x16x32_bf16 v[196:199], v[108:111], v[112:115], v[196:199]
  v_max_f32 v216, v216, v152
  v_max_f32 v217, v217, v153
  v_max_f32 v218, v218, v154
  v_mfma_f32_16x16x32_bf16 v[204:207], v[104:107], v[116:119], v[204:207]
  v_max_f32 v219, v219, v155
  v_max_f32 v220, v220, v176
  v_max_f32 v221, v221, v177
  v_mfma_f32_16x16x32_bf16 v[208:211], v[108:111], v[116:119], v[208:211]
  v_max_f32 v222, v222, v178
  v_max_f32 v223, v223, v179
  v_pk_add_f32 v[216:217], v[216:217], s[66:67] op_sel_hi:[1,0]
  v_pk_add_f32 v[218:219], v[218:219], s[66:67] op_sel_hi:[1,0]
  v_pk_add_f32 v[220:221], v[220:221], s[66:67] op_sel_hi:[1,0]
  v_pk_add_f32 v[222:223], v[222:223], s[66:67] op_sel_hi:[1,0]
  v_cvt_pk_bf16_f32 v152, v216, v217
  v_cvt_pk_bf16_f32 v153, v218, v219
  v_cvt_pk_bf16_f32 v154, v220, v221
  v_cvt_pk_bf16_f32 v155, v222, v223
  v_pk_fma_f32 v[216:217], v[156:157], s[64:65], s[64:65] op_sel_hi:[1,0,0] neg_lo:[0,0,1] neg_hi:[0,0,1]
  v_pk_fma_f32 v[218:219], v[158:159], s[64:65], s[64:65] op_sel_hi:[1,0,0] neg_lo:[0,0,1] neg_hi:[0,0,1]
  v_pk_fma_f32 v[220:221], v[180:181], s[64:65], s[64:65] op_sel_hi:[1,0,0] neg_lo:[0,0,1] neg_hi:[0,0,1]
  v_pk_fma_f32 v[222:223], v[182:183], s[64:65], s[64:65] op_sel_hi:[1,0,0] neg_lo:[0,0,1] neg_hi:[0,0,1]
  v_exp_f32_e64 v216, v216 clamp
  v_exp_f32_e64 v217, v217 clamp
  v_exp_f32_e64 v218, v218 clamp
  v_exp_f32_e64 v219, v219 clamp
  v_exp_f32_e64 v220, v220 clamp
  v_exp_f32_e64 v221, v221 clamp
  v_exp_f32_e64 v222, v222 clamp
  v_exp_f32_e64 v223, v223 clamp
  v_max_f32 v216, v216, v156
  v_max_f32 v217, v217, v157
  v_max_f32 v218, v218, v158
  v_max_f32 v219, v219, v159
  v_max_f32 v220, v220, v180
  v_max_f32 v221, v221, v181
  v_max_f32 v222, v222, v182
  v_max_f32 v223, v223, v183
  v_pk_add_f32 v[216:217], v[216:217], s[66:67] op_sel_hi:[1,0]
  v_pk_add_f32 v[218:219], v[218:219], s[66:67] op_sel_hi:[1,0]
  v_pk_add_f32 v[220:221], v[220:221], s[66:67] op_sel_hi:[1,0]
  v_pk_add_f32 v[222:223], v[222:223], s[66:67] op_sel_hi:[1,0]
  v_cvt_pk_bf16_f32 v156, v216, v217
  v_cvt_pk_bf16_f32 v157, v218, v219
  v_cvt_pk_bf16_f32 v158, v220, v221
  v_cvt_pk_bf16_f32 v159, v222, v223
  v_cvt_pk_bf16_f32 v160, v160, v161
  v_cvt_pk_bf16_f32 v161, v162, v163
  v_cvt_pk_bf16_f32 v162, v184, v185
  v_cvt_pk_bf16_f32 v163, v186, v187
  v_cvt_pk_bf16_f32 v164, v164, v165
  v_cvt_pk_bf16_f32 v165, v166, v167
  v_cvt_pk_bf16_f32 v166, v188, v189
  v_cvt_pk_bf16_f32 v167, v190, v191
  v_mfma_f32_16x16x32_bf16 v[200:203], v[152:155], v[224:227], v[200:203]
  v_mfma_f32_16x16x32_bf16 v[212:215], v[156:159], v[224:227], v[212:215]
  v_mfma_f32_16x16x32_bf16 v[192:195], v[152:155], v[160:163], v[192:195]
  v_mfma_f32_16x16x32_bf16 v[196:199], v[156:159], v[160:163], v[196:199]
  v_mfma_f32_16x16x32_bf16 v[204:207], v[152:155], v[164:167], v[204:207]
  v_mfma_f32_16x16x32_bf16 v[208:211], v[156:159], v[164:167], v[208:211]
  s_nop 7
  ds_write_b128 v248, v[200:203] offset:2048
  ds_write_b128 v248, v[212:215] offset:5120
  ds_write_b128 v248, v[192:195] offset:0
  ds_write_b128 v248, v[196:199] offset:1024
  ds_write_b128 v248, v[204:207] offset:3072
  ds_write_b128 v248, v[208:211] offset:4096
  s_waitcnt lgkmcnt(0)
  s_barrier
  .p2align 3
  v_pk_fma_f32 v[216:217], v[0:1], s[64:65], s[64:65] op_sel_hi:[1,0,0] neg_lo:[0,0,1] neg_hi:[0,0,1]
  v_pk_fma_f32 v[218:219], v[2:3], s[64:65], s[64:65] op_sel_hi:[1,0,0] neg_lo:[0,0,1] neg_hi:[0,0,1]
  v_pk_fma_f32 v[220:221], v[4:5], s[64:65], s[64:65] op_sel_hi:[1,0,0] neg_lo:[0,0,1] neg_hi:[0,0,1]
  v_pk_fma_f32 v[222:223], v[6:7], s[64:65], s[64:65] op_sel_hi:[1,0,0] neg_lo:[0,0,1] neg_hi:[0,0,1]
  v_exp_f32_e64 v216, v216 clamp
  v_exp_f32_e64 v217, v217 clamp
  v_exp_f32_e64 v218, v218 clamp
  v_exp_f32_e64 v219, v219 clamp
  v_exp_f32_e64 v220, v220 clamp
  v_exp_f32_e64 v221, v221 clamp
  v_exp_f32_e64 v222, v222 clamp
  v_exp_f32_e64 v223, v223 clamp
  v_max_f32 v216, v216, v0
  v_max_f32 v217, v217, v1
  v_max_f32 v218, v218, v2
  v_max_f32 v219, v219, v3
  v_max_f32 v220, v220, v4
  v_max_f32 v221, v221, v5
  v_max_f32 v222, v222, v6
  v_max_f32 v223, v223, v7
  v_pk_add_f32 v[216:217], v[216:217], s[66:67] op_sel_hi:[1,0]
  v_pk_add_f32 v[218:219], v[218:219], s[66:67] op_sel_hi:[1,0]
  v_pk_add_f32 v[220:221], v[220:221], s[66:67] op_sel_hi:[1,0]
  v_pk_add_f32 v[222:223], v[222:223], s[66:67] op_sel_hi:[1,0]
  v_cvt_pk_bf16_f32 v0, v216, v217
  v_cvt_pk_bf16_f32 v1, v218, v219
  v_cvt_pk_bf16_f32 v2, v220, v221
  v_cvt_pk_bf16_f32 v3, v222, v223
  v_pk_fma_f32 v[216:217], v[24:25], s[64:65], s[64:65] op_sel_hi:[1,0,0] neg_lo:[0,0,1] neg_hi:[0,0,1]
  v_pk_fma_f32 v[218:219], v[26:27], s[64:65], s[64:65] op_sel_hi:[1,0,0] neg_lo:[0,0,1] neg_hi:[0,0,1]
  v_pk_fma_f32 v[220:221], v[28:29], s[64:65], s[64:65] op_sel_hi:[1,0,0] neg_lo:[0,0,1] neg_hi:[0,0,1]
  v_pk_fma_f32 v[222:223], v[30:31], s[64:65], s[64:65] op_sel_hi:[1,0,0] neg_lo:[0,0,1] neg_hi:[0,0,1]
  v_exp_f32_e64 v216, v216 clamp
  v_exp_f32_e64 v217, v217 clamp
  v_exp_f32_e64 v218, v218 clamp
  v_exp_f32_e64 v219, v219 clamp
  v_exp_f32_e64 v220, v220 clamp
  v_exp_f32_e64 v221, v221 clamp
  v_exp_f32_e64 v222, v222 clamp
  v_exp_f32_e64 v223, v223 clamp
  v_max_f32 v216, v216, v24
  v_max_f32 v217, v217, v25
  v_max_f32 v218, v218, v26
  v_max_f32 v219, v219, v27
  v_max_f32 v220, v220, v28
  v_max_f32 v221, v221, v29
  v_max_f32 v222, v222, v30
  v_max_f32 v223, v223, v31
  v_pk_add_f32 v[216:217], v[216:217], s[66:67] op_sel_hi:[1,0]
  v_pk_add_f32 v[218:219], v[218:219], s[66:67] op_sel_hi:[1,0]
  v_pk_add_f32 v[220:221], v[220:221], s[66:67] op_sel_hi:[1,0]
  v_pk_add_f32 v[222:223], v[222:223], s[66:67] op_sel_hi:[1,0]
  v_cvt_pk_bf16_f32 v24, v216, v217
  v_cvt_pk_bf16_f32 v25, v218, v219
  v_cvt_pk_bf16_f32 v26, v220, v221
  v_cvt_pk_bf16_f32 v27, v222, v223
  v_pk_fma_f32 v[216:217], v[48:49], s[64:65], s[64:65] op_sel_hi:[1,0,0] neg_lo:[0,0,1] neg_hi:[0,0,1]
  v_pk_fma_f32 v[218:219], v[50:51], s[64:65], s[64:65] op_sel_hi:[1,0,0] neg_lo:[0,0,1] neg_hi:[0,0,1]
  v_pk_fma_f32 v[220:221], v[52:53], s[64:65], s[64:65] op_sel_hi:[1,0,0] neg_lo:[0,0,1] neg_hi:[0,0,1]
  v_pk_fma_f32 v[222:223], v[54:55], s[64:65], s[64:65] op_sel_hi:[1,0,0] neg_lo:[0,0,1] neg_hi:[0,0,1]
  v_exp_f32_e64 v216, v216 clamp
  v_exp_f32_e64 v217, v217 clamp
  v_exp_f32_e64 v218, v218 clamp
  v_exp_f32_e64 v219, v219 clamp
  v_exp_f32_e64 v220, v220 clamp
  v_exp_f32_e64 v221, v221 clamp
  v_exp_f32_e64 v222, v222 clamp
  v_exp_f32_e64 v223, v223 clamp
  v_max_f32 v216, v216, v48
  v_max_f32 v217, v217, v49
  v_max_f32 v218, v218, v50
  v_max_f32 v219, v219, v51
  v_max_f32 v220, v220, v52
  v_max_f32 v221, v221, v53
  v_max_f32 v222, v222, v54
  v_max_f32 v223, v223, v55
  v_pk_add_f32 v[216:217], v[216:217], s[66:67] op_sel_hi:[1,0]
  v_pk_add_f32 v[218:219], v[218:219], s[66:67] op_sel_hi:[1,0]
  v_pk_add_f32 v[220:221], v[220:221], s[66:67] op_sel_hi:[1,0]
  v_pk_add_f32 v[222:223], v[222:223], s[66:67] op_sel_hi:[1,0]
  v_cvt_pk_bf16_f32 v48, v216, v217
  v_cvt_pk_bf16_f32 v49, v218, v219
  v_cvt_pk_bf16_f32 v50, v220, v221
  v_cvt_pk_bf16_f32 v51, v222, v223
  v_pk_fma_f32 v[216:217], v[72:73], s[64:65], s[64:65] op_sel_hi:[1,0,0] neg_lo:[0,0,1] neg_hi:[0,0,1]
  v_pk_fma_f32 v[218:219], v[74:75], s[64:65], s[64:65] op_sel_hi:[1,0,0] neg_lo:[0,0,1] neg_hi:[0,0,1]
  v_pk_fma_f32 v[220:221], v[76:77], s[64:65], s[64:65] op_sel_hi:[1,0,0] neg_lo:[0,0,1] neg_hi:[0,0,1]
  v_pk_fma_f32 v[222:223], v[78:79], s[64:65], s[64:65] op_sel_hi:[1,0,0] neg_lo:[0,0,1] neg_hi:[0,0,1]
  v_exp_f32_e64 v216, v216 clamp
  v_exp_f32_e64 v217, v217 clamp
  v_exp_f32_e64 v218, v218 clamp
  v_exp_f32_e64 v219, v219 clamp
  v_exp_f32_e64 v220, v220 clamp
  v_exp_f32_e64 v221, v221 clamp
  v_exp_f32_e64 v222, v222 clamp
  v_exp_f32_e64 v223, v223 clamp
  v_max_f32 v216, v216, v72
  v_max_f32 v217, v217, v73
  v_max_f32 v218, v218, v74
  v_max_f32 v219, v219, v75
  v_max_f32 v220, v220, v76
  v_max_f32 v221, v221, v77
  v_max_f32 v222, v222, v78
  v_max_f32 v223, v223, v79
  v_pk_add_f32 v[216:217], v[216:217], s[66:67] op_sel_hi:[1,0]
  v_pk_add_f32 v[218:219], v[218:219], s[66:67] op_sel_hi:[1,0]
  v_pk_add_f32 v[220:221], v[220:221], s[66:67] op_sel_hi:[1,0]
  v_pk_add_f32 v[222:223], v[222:223], s[66:67] op_sel_hi:[1,0]
  v_cvt_pk_bf16_f32 v72, v216, v217
  v_cvt_pk_bf16_f32 v73, v218, v219
  v_cvt_pk_bf16_f32 v74, v220, v221
  v_cvt_pk_bf16_f32 v75, v222, v223
  v_pk_fma_f32 v[216:217], v[96:97], s[64:65], s[64:65] op_sel_hi:[1,0,0] neg_lo:[0,0,1] neg_hi:[0,0,1]
  v_pk_fma_f32 v[218:219], v[98:99], s[64:65], s[64:65] op_sel_hi:[1,0,0] neg_lo:[0,0,1] neg_hi:[0,0,1]
  v_pk_fma_f32 v[220:221], v[100:101], s[64:65], s[64:65] op_sel_hi:[1,0,0] neg_lo:[0,0,1] neg_hi:[0,0,1]
  v_pk_fma_f32 v[222:223], v[102:103], s[64:65], s[64:65] op_sel_hi:[1,0,0] neg_lo:[0,0,1] neg_hi:[0,0,1]
  v_exp_f32_e64 v216, v216 clamp
  v_exp_f32_e64 v217, v217 clamp
  v_exp_f32_e64 v218, v218 clamp
  v_exp_f32_e64 v219, v219 clamp
  v_exp_f32_e64 v220, v220 clamp
  v_exp_f32_e64 v221, v221 clamp
  v_exp_f32_e64 v222, v222 clamp
  v_exp_f32_e64 v223, v223 clamp
  v_max_f32 v216, v216, v96
  v_max_f32 v217, v217, v97
  v_max_f32 v218, v218, v98
  v_max_f32 v219, v219, v99
  v_max_f32 v220, v220, v100
  v_max_f32 v221, v221, v101
  v_max_f32 v222, v222, v102
  v_max_f32 v223, v223, v103
  v_pk_add_f32 v[216:217], v[216:217], s[66:67] op_sel_hi:[1,0]
  v_pk_add_f32 v[218:219], v[218:219], s[66:67] op_sel_hi:[1,0]
  v_pk_add_f32 v[220:221], v[220:221], s[66:67] op_sel_hi:[1,0]
  v_pk_add_f32 v[222:223], v[222:223], s[66:67] op_sel_hi:[1,0]
  v_cvt_pk_bf16_f32 v96, v216, v217
  v_cvt_pk_bf16_f32 v97, v218, v219
  v_cvt_pk_bf16_f32 v98, v220, v221
  v_cvt_pk_bf16_f32 v99, v222, v223
  v_pk_fma_f32 v[216:217], v[120:121], s[64:65], s[64:65] op_sel_hi:[1,0,0] neg_lo:[0,0,1] neg_hi:[0,0,1]
  v_pk_fma_f32 v[218:219], v[122:123], s[64:65], s[64:65] op_sel_hi:[1,0,0] neg_lo:[0,0,1] neg_hi:[0,0,1]
  v_pk_fma_f32 v[220:221], v[124:125], s[64:65], s[64:65] op_sel_hi:[1,0,0] neg_lo:[0,0,1] neg_hi:[0,0,1]
  v_pk_fma_f32 v[222:223], v[126:127], s[64:65], s[64:65] op_sel_hi:[1,0,0] neg_lo:[0,0,1] neg_hi:[0,0,1]
  v_exp_f32_e64 v216, v216 clamp
  v_exp_f32_e64 v217, v217 clamp
  v_exp_f32_e64 v218, v218 clamp
  v_exp_f32_e64 v219, v219 clamp
  v_exp_f32_e64 v220, v220 clamp
  v_exp_f32_e64 v221, v221 clamp
  v_exp_f32_e64 v222, v222 clamp
  v_exp_f32_e64 v223, v223 clamp
  v_max_f32 v216, v216, v120
  v_max_f32 v217, v217, v121
  v_max_f32 v218, v218, v122
  v_max_f32 v219, v219, v123
  v_max_f32 v220, v220, v124
  v_max_f32 v221, v221, v125
  v_max_f32 v222, v222, v126
  v_max_f32 v223, v223, v127
  v_pk_add_f32 v[216:217], v[216:217], s[66:67] op_sel_hi:[1,0]
  v_pk_add_f32 v[218:219], v[218:219], s[66:67] op_sel_hi:[1,0]
  v_pk_add_f32 v[220:221], v[220:221], s[66:67] op_sel_hi:[1,0]
  v_pk_add_f32 v[222:223], v[222:223], s[66:67] op_sel_hi:[1,0]
  v_cvt_pk_bf16_f32 v120, v216, v217
  v_cvt_pk_bf16_f32 v121, v218, v219
  v_cvt_pk_bf16_f32 v122, v220, v221
  v_cvt_pk_bf16_f32 v123, v222, v223
  v_pk_fma_f32 v[216:217], v[144:145], s[64:65], s[64:65] op_sel_hi:[1,0,0] neg_lo:[0,0,1] neg_hi:[0,0,1]
  v_pk_fma_f32 v[218:219], v[146:147], s[64:65], s[64:65] op_sel_hi:[1,0,0] neg_lo:[0,0,1] neg_hi:[0,0,1]
  v_pk_fma_f32 v[220:221], v[148:149], s[64:65], s[64:65] op_sel_hi:[1,0,0] neg_lo:[0,0,1] neg_hi:[0,0,1]
  v_pk_fma_f32 v[222:223], v[150:151], s[64:65], s[64:65] op_sel_hi:[1,0,0] neg_lo:[0,0,1] neg_hi:[0,0,1]
  v_exp_f32_e64 v216, v216 clamp
  v_exp_f32_e64 v217, v217 clamp
  v_exp_f32_e64 v218, v218 clamp
  v_exp_f32_e64 v219, v219 clamp
  v_exp_f32_e64 v220, v220 clamp
  v_exp_f32_e64 v221, v221 clamp
  v_exp_f32_e64 v222, v222 clamp
  v_exp_f32_e64 v223, v223 clamp
  v_max_f32 v216, v216, v144
  v_max_f32 v217, v217, v145
  v_max_f32 v218, v218, v146
  v_max_f32 v219, v219, v147
  v_max_f32 v220, v220, v148
  v_max_f32 v221, v221, v149
  v_max_f32 v222, v222, v150
  v_max_f32 v223, v223, v151
  v_pk_add_f32 v[216:217], v[216:217], s[66:67] op_sel_hi:[1,0]
  v_pk_add_f32 v[218:219], v[218:219], s[66:67] op_sel_hi:[1,0]
  v_pk_add_f32 v[220:221], v[220:221], s[66:67] op_sel_hi:[1,0]
  v_pk_add_f32 v[222:223], v[222:223], s[66:67] op_sel_hi:[1,0]
  v_cvt_pk_bf16_f32 v144, v216, v217
  v_cvt_pk_bf16_f32 v145, v218, v219
  v_cvt_pk_bf16_f32 v146, v220, v221
  v_cvt_pk_bf16_f32 v147, v222, v223
  v_pk_fma_f32 v[216:217], v[168:169], s[64:65], s[64:65] op_sel_hi:[1,0,0] neg_lo:[0,0,1] neg_hi:[0,0,1]
  v_pk_fma_f32 v[218:219], v[170:171], s[64:65], s[64:65] op_sel_hi:[1,0,0] neg_lo:[0,0,1] neg_hi:[0,0,1]
  v_pk_fma_f32 v[220:221], v[172:173], s[64:65], s[64:65] op_sel_hi:[1,0,0] neg_lo:[0,0,1] neg_hi:[0,0,1]
  v_pk_fma_f32 v[222:223], v[174:175], s[64:65], s[64:65] op_sel_hi:[1,0,0] neg_lo:[0,0,1] neg_hi:[0,0,1]
  v_exp_f32_e64 v216, v216 clamp
  v_exp_f32_e64 v217, v217 clamp
  v_exp_f32_e64 v218, v218 clamp
  v_exp_f32_e64 v219, v219 clamp
  v_exp_f32_e64 v220, v220 clamp
  v_exp_f32_e64 v221, v221 clamp
  v_exp_f32_e64 v222, v222 clamp
  v_exp_f32_e64 v223, v223 clamp
  v_max_f32 v216, v216, v168
  v_max_f32 v217, v217, v169
  v_max_f32 v218, v218, v170
  v_max_f32 v219, v219, v171
  v_max_f32 v220, v220, v172
  v_max_f32 v221, v221, v173
  v_max_f32 v222, v222, v174
  v_max_f32 v223, v223, v175
  v_pk_add_f32 v[216:217], v[216:217], s[66:67] op_sel_hi:[1,0]
  v_pk_add_f32 v[218:219], v[218:219], s[66:67] op_sel_hi:[1,0]
  v_pk_add_f32 v[220:221], v[220:221], s[66:67] op_sel_hi:[1,0]
  v_pk_add_f32 v[222:223], v[222:223], s[66:67] op_sel_hi:[1,0]
  v_cvt_pk_bf16_f32 v168, v216, v217
  v_cvt_pk_bf16_f32 v169, v218, v219
  v_cvt_pk_bf16_f32 v170, v220, v221
  v_cvt_pk_bf16_f32 v171, v222, v223
  s_lshl_b32 s46, s41, 6
  s_lshl_b32 s48, s42, 1
  s_add_u32 s46, s46, s48
  s_add_u32 s46, s46, s47
  s_mul_i32 s46, s46, 16384
  s_lshr_b32 s48, s40, 1
  s_lshl_b32 s49, s48, 12
  s_add_u32 s49, s49, s46
  s_add_u32 s48, s49, 8192

  s_setprio 3
  s_barrier
  ds_read_b128 v[228:231], v249 offset:0
  ds_read_b128 v[232:235], v249 offset:1024
  ds_read_b128 v[236:239], v249 offset:2048
  s_waitcnt lgkmcnt(0)
  v_mfma_f32_16x16x32_bf16 v[16:19], v[236:239], v[0:3], 0
  v_mfma_f32_16x16x32_bf16 v[8:11], v[228:231], v[0:3], 0
  v_mfma_f32_16x16x32_bf16 v[12:15], v[232:235], v[0:3], 0
  v_mfma_f32_16x16x32_bf16 v[40:43], v[236:239], v[24:27], 0
  v_mfma_f32_16x16x32_bf16 v[32:35], v[228:231], v[24:27], 0
  v_mfma_f32_16x16x32_bf16 v[36:39], v[232:235], v[24:27], 0
  s_nop 2
  .p2align 3
  v_add_f32 v16, s66, v16
  v_rcp_f32 v16, v16
  v_mfma_f32_16x16x32_bf16 v[64:67], v[236:239], v[48:51], 0
  v_pk_mul_f32 v[8:9], v[8:9], v[16:17] op_sel_hi:[1,0]
  v_pk_mul_f32 v[10:11], v[10:11], v[16:17] op_sel_hi:[1,0]
  v_pk_mul_f32 v[12:13], v[12:13], v[16:17] op_sel_hi:[1,0]
  v_mfma_f32_16x16x32_bf16 v[56:59], v[228:231], v[48:51], 0
  v_pk_mul_f32 v[14:15], v[14:15], v[16:17] op_sel_hi:[1,0]
  v_cvt_pk_bf16_f32 v8, v8, v9
  v_cvt_pk_bf16_f32 v9, v10, v11
  v_mfma_f32_16x16x32_bf16 v[60:63], v[232:235], v[48:51], 0
  v_cvt_pk_bf16_f32 v10, v12, v13
  v_cvt_pk_bf16_f32 v11, v14, v15
  buffer_store_dwordx4 v[8:11], v253, s[32:35], s48 offen offset:0 sc1
  v_add_f32 v40, s66, v40
  v_rcp_f32 v40, v40
  v_mfma_f32_16x16x32_bf16 v[88:91], v[236:239], v[72:75], 0
  v_pk_mul_f32 v[32:33], v[32:33], v[40:41] op_sel_hi:[1,0]
  v_pk_mul_f32 v[34:35], v[34:35], v[40:41] op_sel_hi:[1,0]
  v_pk_mul_f32 v[36:37], v[36:37], v[40:41] op_sel_hi:[1,0]
  v_mfma_f32_16x16x32_bf16 v[80:83], v[228:231], v[72:75], 0
  v_pk_mul_f32 v[38:39], v[38:39], v[40:41] op_sel_hi:[1,0]
  v_cvt_pk_bf16_f32 v32, v32, v33
  v_cvt_pk_bf16_f32 v33, v34, v35
  v_mfma_f32_16x16x32_bf16 v[84:87], v[232:235], v[72:75], 0
  v_cvt_pk_bf16_f32 v34, v36, v37
  v_cvt_pk_bf16_f32 v35, v38, v39
  buffer_store_dwordx4 v[32:35], v253, s[32:35], s48 offen offset:1024 sc1
  v_add_f32 v64, s66, v64
  v_rcp_f32 v64, v64
  v_mfma_f32_16x16x32_bf16 v[112:115], v[236:239], v[96:99], 0
  v_pk_mul_f32 v[56:57], v[56:57], v[64:65] op_sel_hi:[1,0]
  v_pk_mul_f32 v[58:59], v[58:59], v[64:65] op_sel_hi:[1,0]
  v_pk_mul_f32 v[60:61], v[60:61], v[64:65] op_sel_hi:[1,0]
  v_mfma_f32_16x16x32_bf16 v[104:107], v[228:231], v[96:99], 0
  v_pk_mul_f32 v[62:63], v[62:63], v[64:65] op_sel_hi:[1,0]
  v_cvt_pk_bf16_f32 v56, v56, v57
  v_cvt_pk_bf16_f32 v57, v58, v59
  v_mfma_f32_16x16x32_bf16 v[108:111], v[232:235], v[96:99], 0
  v_cvt_pk_bf16_f32 v58, v60, v61
  v_cvt_pk_bf16_f32 v59, v62, v63
  buffer_store_dwordx4 v[56:59], v253, s[32:35], s48 offen offset:2048 sc1
  v_add_f32 v88, s66, v88
  v_rcp_f32 v88, v88
  v_mfma_f32_16x16x32_bf16 v[136:139], v[236:239], v[120:123], 0
  v_pk_mul_f32 v[80:81], v[80:81], v[88:89] op_sel_hi:[1,0]
  v_pk_mul_f32 v[82:83], v[82:83], v[88:89] op_sel_hi:[1,0]
  v_pk_mul_f32 v[84:85], v[84:85], v[88:89] op_sel_hi:[1,0]
  v_mfma_f32_16x16x32_bf16 v[128:131], v[228:231], v[120:123], 0
  v_pk_mul_f32 v[86:87], v[86:87], v[88:89] op_sel_hi:[1,0]
  v_cvt_pk_bf16_f32 v80, v80, v81
  v_cvt_pk_bf16_f32 v81, v82, v83
  v_mfma_f32_16x16x32_bf16 v[132:135], v[232:235], v[120:123], 0
  v_cvt_pk_bf16_f32 v82, v84, v85
  v_cvt_pk_bf16_f32 v83, v86, v87
  buffer_store_dwordx4 v[80:83], v253, s[32:35], s48 offen offset:3072 sc1
  v_add_f32 v112, s66, v112
  v_rcp_f32 v112, v112
  v_mfma_f32_16x16x32_bf16 v[160:163], v[236:239], v[144:147], 0
  v_pk_mul_f32 v[104:105], v[104:105], v[112:113] op_sel_hi:[1,0]
  v_pk_mul_f32 v[106:107], v[106:107], v[112:113] op_sel_hi:[1,0]
  v_pk_mul_f32 v[108:109], v[108:109], v[112:113] op_sel_hi:[1,0]
  v_mfma_f32_16x16x32_bf16 v[152:155], v[228:231], v[144:147], 0
  v_pk_mul_f32 v[110:111], v[110:111], v[112:113] op_sel_hi:[1,0]
  v_cvt_pk_bf16_f32 v104, v104, v105
  v_cvt_pk_bf16_f32 v105, v106, v107
  v_mfma_f32_16x16x32_bf16 v[156:159], v[232:235], v[144:147], 0
  v_cvt_pk_bf16_f32 v106, v108, v109
  v_cvt_pk_bf16_f32 v107, v110, v111
  buffer_store_dwordx4 v[104:107], v253, s[32:35], s49 offen offset:0 sc1
  v_add_f32 v136, s66, v136
  v_rcp_f32 v136, v136
  v_mfma_f32_16x16x32_bf16 v[184:187], v[236:239], v[168:171], 0
  v_pk_mul_f32 v[128:129], v[128:129], v[136:137] op_sel_hi:[1,0]
  v_pk_mul_f32 v[130:131], v[130:131], v[136:137] op_sel_hi:[1,0]
  v_pk_mul_f32 v[132:133], v[132:133], v[136:137] op_sel_hi:[1,0]
  v_mfma_f32_16x16x32_bf16 v[176:179], v[228:231], v[168:171], 0
  v_pk_mul_f32 v[134:135], v[134:135], v[136:137] op_sel_hi:[1,0]
  v_cvt_pk_bf16_f32 v128, v128, v129
  v_cvt_pk_bf16_f32 v129, v130, v131
  v_mfma_f32_16x16x32_bf16 v[180:183], v[232:235], v[168:171], 0
  v_cvt_pk_bf16_f32 v130, v132, v133
  v_cvt_pk_bf16_f32 v131, v134, v135
  buffer_store_dwordx4 v[128:131], v253, s[32:35], s49 offen offset:1024 sc1
  v_add_f32 v160, s66, v160
  v_rcp_f32 v160, v160
  v_nop_e64
  v_pk_mul_f32 v[152:153], v[152:153], v[160:161] op_sel_hi:[1,0]
  v_pk_mul_f32 v[154:155], v[154:155], v[160:161] op_sel_hi:[1,0]
  v_pk_mul_f32 v[156:157], v[156:157], v[160:161] op_sel_hi:[1,0]
  v_pk_mul_f32 v[158:159], v[158:159], v[160:161] op_sel_hi:[1,0]
  v_cvt_pk_bf16_f32 v152, v152, v153
  v_cvt_pk_bf16_f32 v153, v154, v155
  v_cvt_pk_bf16_f32 v154, v156, v157
  v_cvt_pk_bf16_f32 v155, v158, v159
  buffer_store_dwordx4 v[152:155], v253, s[32:35], s49 offen offset:2048 sc1
  v_add_f32 v184, s66, v184
  v_rcp_f32 v184, v184
  v_nop_e64
  v_pk_mul_f32 v[176:177], v[176:177], v[184:185] op_sel_hi:[1,0]
  v_pk_mul_f32 v[178:179], v[178:179], v[184:185] op_sel_hi:[1,0]
  v_pk_mul_f32 v[180:181], v[180:181], v[184:185] op_sel_hi:[1,0]
  v_pk_mul_f32 v[182:183], v[182:183], v[184:185] op_sel_hi:[1,0]
  v_cvt_pk_bf16_f32 v176, v176, v177
  v_cvt_pk_bf16_f32 v177, v178, v179
  v_cvt_pk_bf16_f32 v178, v180, v181
  v_cvt_pk_bf16_f32 v179, v182, v183
  buffer_store_dwordx4 v[176:179], v253, s[32:35], s49 offen offset:3072 sc1
  s_lshl_b32 s46, s40, 7
  s_add_u32 s46, s46, s63
  v_mov_b32 v250, 1
  v_lshlrev_b32 v251, 2, v252
  s_mov_b32 exec_hi, 0
  s_waitcnt vmcnt(0)
  buffer_store_dword v250, v251, s[32:35], s46 offen offset:1024 sc1
  s_mov_b32 exec_hi, -1

  s_barrier
  s_setprio 0
  v_lshlrev_b32 v224, 4, v252
  v_lshrrev_b32 v230, 2, v252
  v_lshlrev_b32 v230, 7, v230
  v_bfe_u32 v231, v252, 3, 2
  v_lshl_add_u32 v230, v231, 5, v230
  v_and_b32 v231, 3, v252
  v_lshl_add_u32 v230, v231, 3, v230
  v_add_u32 v226, 65536, v230
  v_xor_b32 v227, 32, v226
  v_xor_b32 v228, 64, v226
  v_xor_b32 v229, 96, v226

  s_mul_i32 s59, s78, 1048576
  s_add_u32 s26, s59, 1048576
  s_lshl_b32 s47, s77, 13
  s_add_u32 s59, s59, s47
  s_lshl_b32 s47, s40, 11
  s_add_u32 s59, s59, s47
  v_mov_b32 v230, 0
  v_mov_b32 v231, 0
  v_mov_b32 v232, 0
  v_mov_b32 v233, 0
  s_mov_b32 s28, s18
  s_and_b32 s29, s19, 0xffff
  s_mov_b32 s30, 0x400000
  s_mov_b32 s53, 32768
  s_mov_b32 s24, s32
  s_mov_b32 s25, s33
  s_movk_i32 s61, 0x108

  s_barrier
  buffer_load_dwordx4 v[160:163], v224, s[24:27], s59 offen offset:0 sc1
  buffer_load_dwordx4 v[164:167], v224, s[24:27], s59 offen offset:1024 sc1
  s_add_u32 s59, s59, 16384
  buffer_load_dwordx4 v[168:171], v224, s[24:27], s59 offen offset:0 sc1
  buffer_load_dwordx4 v[172:175], v224, s[24:27], s59 offen offset:1024 sc1
  s_add_u32 s59, s59, 16384
  buffer_load_dwordx4 v[176:179], v224, s[24:27], s59 offen offset:0 sc1
  buffer_load_dwordx4 v[180:183], v224, s[24:27], s59 offen offset:1024 sc1
  s_add_u32 s59, s59, 16384
  buffer_load_dwordx4 v[184:187], v224, s[24:27], s59 offen offset:0 sc1
  buffer_load_dwordx4 v[188:191], v224, s[24:27], s59 offen offset:1024 sc1
  s_add_u32 s59, s59, 16384
  buffer_load_dwordx4 v[192:195], v224, s[24:27], s59 offen offset:0 sc1
  buffer_load_dwordx4 v[196:199], v224, s[24:27], s59 offen offset:1024 sc1
  s_add_u32 s59, s59, 16384
  buffer_load_dwordx4 v[200:203], v224, s[24:27], s59 offen offset:0 sc1
  buffer_load_dwordx4 v[204:207], v224, s[24:27], s59 offen offset:1024 sc1
  s_add_u32 s59, s59, 16384
  buffer_load_dwordx4 v[208:211], v224, s[24:27], s59 offen offset:0 sc1
  buffer_load_dwordx4 v[212:215], v224, s[24:27], s59 offen offset:1024 sc1
  s_add_u32 s59, s59, 16384
L_fcons:
  v_mfma_f32_32x32x16_bf16 v[0:15], v[230:233], v[230:233], 0
  v_mfma_f32_32x32x16_bf16 v[16:31], v[230:233], v[230:233], 0
  s_mov_b32 s50, 0
  ds_read_b64_tr_b16 v[64:65], v226 offset:0
  ds_read_b64_tr_b16 v[66:67], v226 offset:2048
  ds_read_b64_tr_b16 v[68:69], v227 offset:0
  ds_read_b64_tr_b16 v[70:71], v227 offset:2048
  ds_read_b64_tr_b16 v[72:73], v228 offset:0
  ds_read_b64_tr_b16 v[74:75], v228 offset:2048
  ds_read_b64_tr_b16 v[76:77], v229 offset:0
  ds_read_b64_tr_b16 v[78:79], v229 offset:2048
  v_and_b32 v96, 15, v252
  v_lshlrev_b32 v97, 2, v96
  s_lshl_b32 s47, s40, 7
  v_add_u32 v110, s47, v97
  v_lshlrev_b32 v96, 11, v96

  v_bfe_u32 v97, v252, 4, 1
  v_lshl_add_u32 v96, v97, 5, v96
  v_lshrrev_b32 v97, 5, v252
  v_lshl_add_u32 v96, v97, 4, v96
  s_lshl_b32 s48, s78, 1
  s_add_u32 s48, s48, s77
  s_lshl_b32 s48, s48, 2
  s_add_u32 s48, s48, s40
  s_lshl_b32 s48, s48, 16
  s_lshl_b32 s49, s79, 7
  s_add_u32 s48, s48, s49

  v_and_b32 v108, 7, v252
  v_bfe_u32 v106, v96, 4, 2
  v_xor_b32 v106, v106, v108
  v_lshlrev_b32 v106, 4, v106
  v_and_b32 v109, 15, v252
  v_lshl_add_u32 v106, v109, 7, v106
  s_lshl_b32 s47, s40, 12
  s_add_u32 s47, s47, 32768
  v_add_u32 v106, s47, v106
  v_xor_b32 v107, 64, v106
  v_lshrrev_b32 v97, 3, v252
  v_lshlrev_b32 v109, 4, v108
  v_lshl_add_u32 v109, v97, 11, v109
  v_xor_b32 v108, v108, v97
  v_lshlrev_b32 v108, 4, v108
  v_lshl_add_u32 v108, v97, 7, v108
  v_add_u32 v108, s47, v108

L2_loop:
  s_waitcnt vmcnt(12) lgkmcnt(4)
  v_mfma_f32_16x16x32_bf16 v[0:3], v[64:67], v[160:163], v[0:3]
  ds_read_b64_tr_b16 v[80:81], v226 offset:4096
  ds_read_b64_tr_b16 v[82:83], v226 offset:6144
  v_mfma_f32_16x16x32_bf16 v[16:19], v[64:67], v[164:167], v[16:19]
  ds_read_b64_tr_b16 v[84:85], v227 offset:4096
  ds_read_b64_tr_b16 v[86:87], v227 offset:6144
  v_mfma_f32_16x16x32_bf16 v[20:23], v[68:71], v[164:167], v[20:23]
  ds_read_b64_tr_b16 v[88:89], v228 offset:4096
  ds_read_b64_tr_b16 v[90:91], v228 offset:6144
  v_mfma_f32_16x16x32_bf16 v[4:7], v[68:71], v[160:163], v[4:7]
  ds_read_b64_tr_b16 v[92:93], v229 offset:4096
  ds_read_b64_tr_b16 v[94:95], v229 offset:6144
  s_waitcnt lgkmcnt(8)
  v_mfma_f32_16x16x32_bf16 v[8:11], v[72:75], v[160:163], v[8:11]
  buffer_load_dwordx4 v[216:219], v224, s[24:27], s59 offen offset:0 sc1
  v_mfma_f32_16x16x32_bf16 v[24:27], v[72:75], v[164:167], v[24:27]
  buffer_load_dwordx4 v[220:223], v224, s[24:27], s59 offen offset:1024 sc1
  s_add_u32 s59, s59, 16384
  v_mfma_f32_16x16x32_bf16 v[28:31], v[76:79], v[164:167], v[28:31]
  v_mfma_f32_16x16x32_bf16 v[12:15], v[76:79], v[160:163], v[12:15]
  s_waitcnt vmcnt(12) lgkmcnt(4)
  v_mfma_f32_16x16x32_bf16 v[0:3], v[80:83], v[168:171], v[0:3]
  ds_read_b64_tr_b16 v[64:65], v226 offset:8192
  ds_read_b64_tr_b16 v[66:67], v226 offset:10240
  v_mfma_f32_16x16x32_bf16 v[16:19], v[80:83], v[172:175], v[16:19]
  ds_read_b64_tr_b16 v[68:69], v227 offset:8192
  ds_read_b64_tr_b16 v[70:71], v227 offset:10240
  v_mfma_f32_16x16x32_bf16 v[20:23], v[84:87], v[172:175], v[20:23]
  ds_read_b64_tr_b16 v[72:73], v228 offset:8192
  ds_read_b64_tr_b16 v[74:75], v228 offset:10240
  v_mfma_f32_16x16x32_bf16 v[4:7], v[84:87], v[168:171], v[4:7]
  ds_read_b64_tr_b16 v[76:77], v229 offset:8192
  ds_read_b64_tr_b16 v[78:79], v229 offset:10240
  s_waitcnt lgkmcnt(8)
  v_mfma_f32_16x16x32_bf16 v[8:11], v[88:91], v[168:171], v[8:11]
  buffer_load_dwordx4 v[160:163], v224, s[24:27], s59 offen offset:0 sc1
  v_mfma_f32_16x16x32_bf16 v[24:27], v[88:91], v[172:175], v[24:27]
  buffer_load_dwordx4 v[164:167], v224, s[24:27], s59 offen offset:1024 sc1
  s_add_u32 s59, s59, 16384
  v_mfma_f32_16x16x32_bf16 v[28:31], v[92:95], v[172:175], v[28:31]
  v_mfma_f32_16x16x32_bf16 v[12:15], v[92:95], v[168:171], v[12:15]
  s_waitcnt vmcnt(12) lgkmcnt(4)
  v_mfma_f32_16x16x32_bf16 v[0:3], v[64:67], v[176:179], v[0:3]
  ds_read_b64_tr_b16 v[80:81], v226 offset:12288
  ds_read_b64_tr_b16 v[82:83], v226 offset:14336
  v_mfma_f32_16x16x32_bf16 v[16:19], v[64:67], v[180:183], v[16:19]
  ds_read_b64_tr_b16 v[84:85], v227 offset:12288
  ds_read_b64_tr_b16 v[86:87], v227 offset:14336
  v_mfma_f32_16x16x32_bf16 v[20:23], v[68:71], v[180:183], v[20:23]
  ds_read_b64_tr_b16 v[88:89], v228 offset:12288
  ds_read_b64_tr_b16 v[90:91], v228 offset:14336
  v_mfma_f32_16x16x32_bf16 v[4:7], v[68:71], v[176:179], v[4:7]
  ds_read_b64_tr_b16 v[92:93], v229 offset:12288
  ds_read_b64_tr_b16 v[94:95], v229 offset:14336
  s_waitcnt lgkmcnt(8)
  v_mfma_f32_16x16x32_bf16 v[8:11], v[72:75], v[176:179], v[8:11]
  buffer_load_dwordx4 v[168:171], v224, s[24:27], s59 offen offset:0 sc1
  v_mfma_f32_16x16x32_bf16 v[24:27], v[72:75], v[180:183], v[24:27]
  buffer_load_dwordx4 v[172:175], v224, s[24:27], s59 offen offset:1024 sc1
  s_add_u32 s59, s59, 16384
  v_mfma_f32_16x16x32_bf16 v[28:31], v[76:79], v[180:183], v[28:31]
  ds_read_b32 v98, v110 offset:512
  ds_read_b32 v102, v110 offset:576
  v_mfma_f32_16x16x32_bf16 v[12:15], v[76:79], v[176:179], v[12:15]
  s_waitcnt vmcnt(12) lgkmcnt(6)
  v_mfma_f32_16x16x32_bf16 v[0:3], v[80:83], v[184:187], v[0:3]
  ds_read_b64_tr_b16 v[64:65], v226 offset:16384
  ds_read_b64_tr_b16 v[66:67], v226 offset:18432
  v_mfma_f32_16x16x32_bf16 v[16:19], v[80:83], v[188:191], v[16:19]
  ds_read_b64_tr_b16 v[68:69], v227 offset:16384
  ds_read_b64_tr_b16 v[70:71], v227 offset:18432
  v_mfma_f32_16x16x32_bf16 v[20:23], v[84:87], v[188:191], v[20:23]
  ds_read_b64_tr_b16 v[72:73], v228 offset:16384
  ds_read_b64_tr_b16 v[74:75], v228 offset:18432
  v_mfma_f32_16x16x32_bf16 v[4:7], v[84:87], v[184:187], v[4:7]
  ds_read_b64_tr_b16 v[76:77], v229 offset:16384
  ds_read_b64_tr_b16 v[78:79], v229 offset:18432
  s_waitcnt lgkmcnt(10)
  v_mfma_f32_16x16x32_bf16 v[8:11], v[88:91], v[184:187], v[8:11]
  buffer_load_dwordx4 v[176:179], v224, s[24:27], s59 offen offset:0 sc1
  v_mfma_f32_16x16x32_bf16 v[24:27], v[88:91], v[188:191], v[24:27]
  buffer_load_dwordx4 v[180:183], v224, s[24:27], s59 offen offset:1024 sc1
  s_add_u32 s59, s59, 16384
  v_mfma_f32_16x16x32_bf16 v[28:31], v[92:95], v[188:191], v[28:31]
  v_mfma_f32_16x16x32_bf16 v[12:15], v[92:95], v[184:187], v[12:15]
  s_waitcnt vmcnt(12) lgkmcnt(4)
  v_mfma_f32_16x16x32_bf16 v[0:3], v[64:67], v[192:195], v[0:3]
  ds_read_b64_tr_b16 v[80:81], v226 offset:20480
  ds_read_b64_tr_b16 v[82:83], v226 offset:22528
  v_mfma_f32_16x16x32_bf16 v[16:19], v[64:67], v[196:199], v[16:19]
  ds_read_b64_tr_b16 v[84:85], v227 offset:20480
  ds_read_b64_tr_b16 v[86:87], v227 offset:22528
  v_mfma_f32_16x16x32_bf16 v[20:23], v[68:71], v[196:199], v[20:23]
  ds_read_b64_tr_b16 v[88:89], v228 offset:20480
  ds_read_b64_tr_b16 v[90:91], v228 offset:22528
  v_mfma_f32_16x16x32_bf16 v[4:7], v[68:71], v[192:195], v[4:7]
  ds_read_b64_tr_b16 v[92:93], v229 offset:20480
  ds_read_b64_tr_b16 v[94:95], v229 offset:22528
  s_waitcnt lgkmcnt(8)
  v_mfma_f32_16x16x32_bf16 v[8:11], v[72:75], v[192:195], v[8:11]
  buffer_load_dwordx4 v[184:187], v224, s[24:27], s59 offen offset:0 sc1
  v_mfma_f32_16x16x32_bf16 v[24:27], v[72:75], v[196:199], v[24:27]
  buffer_load_dwordx4 v[188:191], v224, s[24:27], s59 offen offset:1024 sc1
  s_add_u32 s59, s59, 16384
  v_mfma_f32_16x16x32_bf16 v[28:31], v[76:79], v[196:199], v[28:31]
  s_add_u32 s50, s50, 1
  v_mfma_f32_16x16x32_bf16 v[12:15], v[76:79], v[192:195], v[12:15]
  s_waitcnt vmcnt(12) lgkmcnt(4)
  v_mfma_f32_16x16x32_bf16 v[0:3], v[80:83], v[200:203], v[0:3]
  ds_read_b64_tr_b16 v[64:65], v226 offset:24576
  ds_read_b64_tr_b16 v[66:67], v226 offset:26624
  v_mfma_f32_16x16x32_bf16 v[16:19], v[80:83], v[204:207], v[16:19]
  ds_read_b64_tr_b16 v[68:69], v227 offset:24576
  ds_read_b64_tr_b16 v[70:71], v227 offset:26624
  v_mfma_f32_16x16x32_bf16 v[20:23], v[84:87], v[204:207], v[20:23]
  ds_read_b64_tr_b16 v[72:73], v228 offset:24576
  ds_read_b64_tr_b16 v[74:75], v228 offset:26624
  v_mfma_f32_16x16x32_bf16 v[4:7], v[84:87], v[200:203], v[4:7]
  ds_read_b64_tr_b16 v[76:77], v229 offset:24576
  ds_read_b64_tr_b16 v[78:79], v229 offset:26624
  s_waitcnt lgkmcnt(8)
  v_mfma_f32_16x16x32_bf16 v[8:11], v[88:91], v[200:203], v[8:11]
  buffer_load_dwordx4 v[192:195], v224, s[24:27], s59 offen offset:0 sc1
  v_mfma_f32_16x16x32_bf16 v[24:27], v[88:91], v[204:207], v[24:27]
  buffer_load_dwordx4 v[196:199], v224, s[24:27], s59 offen offset:1024 sc1
  s_add_u32 s59, s59, 16384
  v_mfma_f32_16x16x32_bf16 v[28:31], v[92:95], v[204:207], v[28:31]
  s_bitcmp1_b32 s61, s50
  s_cselect_b32 s52, 4294836224, s53
  v_mfma_f32_16x16x32_bf16 v[12:15], v[92:95], v[200:203], v[12:15]
  s_waitcnt vmcnt(12) lgkmcnt(4)
  v_mfma_f32_16x16x32_bf16 v[0:3], v[64:67], v[208:211], v[0:3]
  ds_read_b64_tr_b16 v[80:81], v226 offset:28672
  ds_read_b64_tr_b16 v[82:83], v226 offset:30720
  v_mfma_f32_16x16x32_bf16 v[16:19], v[64:67], v[212:215], v[16:19]
  ds_read_b64_tr_b16 v[84:85], v227 offset:28672
  ds_read_b64_tr_b16 v[86:87], v227 offset:30720
  v_mfma_f32_16x16x32_bf16 v[20:23], v[68:71], v[212:215], v[20:23]
  ds_read_b64_tr_b16 v[88:89], v228 offset:28672
  ds_read_b64_tr_b16 v[90:91], v228 offset:30720
  v_mfma_f32_16x16x32_bf16 v[4:7], v[68:71], v[208:211], v[4:7]
  ds_read_b64_tr_b16 v[92:93], v229 offset:28672
  ds_read_b64_tr_b16 v[94:95], v229 offset:30720
  s_waitcnt lgkmcnt(8)
  v_mfma_f32_16x16x32_bf16 v[8:11], v[72:75], v[208:211], v[8:11]
  buffer_load_dwordx4 v[200:203], v224, s[24:27], s59 offen offset:0 sc1
  v_mfma_f32_16x16x32_bf16 v[24:27], v[72:75], v[212:215], v[24:27]
  buffer_load_dwordx4 v[204:207], v224, s[24:27], s59 offen offset:1024 sc1
  s_add_u32 s59, s59, 16384
  v_mfma_f32_16x16x32_bf16 v[28:31], v[76:79], v[212:215], v[28:31]
  v_add_u32 v226, s52, v226
  v_add_u32 v227, s52, v227
  v_mfma_f32_16x16x32_bf16 v[12:15], v[76:79], v[208:211], v[12:15]
  v_add_u32 v228, s52, v228
  v_add_u32 v229, s52, v229
  s_waitcnt vmcnt(12) lgkmcnt(4)
  v_mfma_f32_16x16x32_bf16 v[0:3], v[80:83], v[216:219], v[0:3]
  s_waitcnt lgkmcnt(0)
  s_barrier
  ds_read_b64_tr_b16 v[64:65], v226 offset:0
  ds_read_b64_tr_b16 v[66:67], v226 offset:2048
  v_mfma_f32_16x16x32_bf16 v[16:19], v[80:83], v[220:223], v[16:19]
  ds_read_b64_tr_b16 v[68:69], v227 offset:0
  ds_read_b64_tr_b16 v[70:71], v227 offset:2048
  v_mfma_f32_16x16x32_bf16 v[20:23], v[84:87], v[220:223], v[20:23]
  ds_read_b64_tr_b16 v[72:73], v228 offset:0
  ds_read_b64_tr_b16 v[74:75], v228 offset:2048
  v_mfma_f32_16x16x32_bf16 v[4:7], v[84:87], v[216:219], v[4:7]
  ds_read_b64_tr_b16 v[76:77], v229 offset:0
  ds_read_b64_tr_b16 v[78:79], v229 offset:2048
  v_mfma_f32_16x16x32_bf16 v[8:11], v[88:91], v[216:219], v[8:11]
  buffer_load_dwordx4 v[208:211], v224, s[24:27], s59 offen offset:0 sc1
  v_mfma_f32_16x16x32_bf16 v[24:27], v[88:91], v[220:223], v[24:27]
  buffer_load_dwordx4 v[212:215], v224, s[24:27], s59 offen offset:1024 sc1
  s_add_u32 s59, s59, 16384
  v_mfma_f32_16x16x32_bf16 v[28:31], v[92:95], v[220:223], v[28:31]
  s_and_b32 s47, s50, 3
  v_mfma_f32_16x16x32_bf16 v[12:15], v[92:95], v[216:219], v[12:15]
  s_cbranch_scc1 L2_loop
  s_cmp_eq_u32 s50, 8
  s_cbranch_scc1 L2_done
  s_nop 4

  .p2align 3
  v_pk_mul_f32 v[32:33], v[0:1], 1.0 op_sel_hi:[1,0]
  v_pk_mul_f32 v[34:35], v[2:3], 1.0 op_sel_hi:[1,0]
  v_pk_mul_f32 v[36:37], v[4:5], 1.0 op_sel_hi:[1,0]
  v_pk_mul_f32 v[38:39], v[6:7], 1.0 op_sel_hi:[1,0]
  v_pk_mul_f32 v[40:41], v[8:9], 1.0 op_sel_hi:[1,0]
  v_pk_mul_f32 v[42:43], v[10:11], 1.0 op_sel_hi:[1,0]
  v_pk_mul_f32 v[44:45], v[12:13], 1.0 op_sel_hi:[1,0]
  v_pk_mul_f32 v[46:47], v[14:15], 1.0 op_sel_hi:[1,0]
  v_pk_mul_f32 v[48:49], v[16:17], 1.0 op_sel_hi:[1,0]
  v_pk_mul_f32 v[50:51], v[18:19], 1.0 op_sel_hi:[1,0]
  v_pk_mul_f32 v[52:53], v[20:21], 1.0 op_sel_hi:[1,0]
  v_pk_mul_f32 v[54:55], v[22:23], 1.0 op_sel_hi:[1,0]
  v_pk_mul_f32 v[56:57], v[24:25], 1.0 op_sel_hi:[1,0]
  v_pk_mul_f32 v[58:59], v[26:27], 1.0 op_sel_hi:[1,0]
  v_pk_mul_f32 v[60:61], v[28:29], 1.0 op_sel_hi:[1,0]
  v_pk_mul_f32 v[62:63], v[30:31], 1.0 op_sel_hi:[1,0]
  s_branch L2_loop
L2_done:
  s_nop 1
  v_sub_f32 v100, 1.0, v98
  v_sub_f32 v98, v98, v100
  .p2align 3
  v_pk_mul_f32 v[32:33], v[32:33], v[98:99] op_sel_hi:[1,0]
  v_pk_mul_f32 v[34:35], v[34:35], v[98:99] op_sel_hi:[1,0]
  v_pk_mul_f32 v[36:37], v[36:37], v[98:99] op_sel_hi:[1,0]
  v_pk_mul_f32 v[38:39], v[38:39], v[98:99] op_sel_hi:[1,0]
  v_pk_fma_f32 v[0:1], v[0:1], v[100:101], v[32:33] op_sel_hi:[1,0,1]
  v_pk_fma_f32 v[2:3], v[2:3], v[100:101], v[34:35] op_sel_hi:[1,0,1]
  v_pk_fma_f32 v[4:5], v[4:5], v[100:101], v[36:37] op_sel_hi:[1,0,1]
  v_pk_fma_f32 v[6:7], v[6:7], v[100:101], v[38:39] op_sel_hi:[1,0,1]
  v_cvt_pk_bf16_f32 v0, v0, v1
  v_cvt_pk_bf16_f32 v1, v2, v3
  v_cvt_pk_bf16_f32 v2, v4, v5
  v_cvt_pk_bf16_f32 v3, v6, v7
  s_nop 1
  v_permlane16_swap_b32 v0, v2
  v_permlane16_swap_b32 v1, v3
  ds_write_b128 v106, v[0:3] offset:0
  .p2align 3
  v_pk_mul_f32 v[40:41], v[40:41], v[98:99] op_sel_hi:[1,0]
  v_pk_mul_f32 v[42:43], v[42:43], v[98:99] op_sel_hi:[1,0]
  v_pk_mul_f32 v[44:45], v[44:45], v[98:99] op_sel_hi:[1,0]
  v_pk_mul_f32 v[46:47], v[46:47], v[98:99] op_sel_hi:[1,0]
  v_pk_fma_f32 v[8:9], v[8:9], v[100:101], v[40:41] op_sel_hi:[1,0,1]
  v_pk_fma_f32 v[10:11], v[10:11], v[100:101], v[42:43] op_sel_hi:[1,0,1]
  v_pk_fma_f32 v[12:13], v[12:13], v[100:101], v[44:45] op_sel_hi:[1,0,1]
  v_pk_fma_f32 v[14:15], v[14:15], v[100:101], v[46:47] op_sel_hi:[1,0,1]
  v_cvt_pk_bf16_f32 v8, v8, v9
  v_cvt_pk_bf16_f32 v9, v10, v11
  v_cvt_pk_bf16_f32 v10, v12, v13
  v_cvt_pk_bf16_f32 v11, v14, v15
  s_nop 1
  v_permlane16_swap_b32 v8, v10
  v_permlane16_swap_b32 v9, v11
  ds_write_b128 v107, v[8:11] offset:0
  ds_read_b128 v[64:67], v108 offset:0
  ds_read_b128 v[68:71], v108 offset:1024
  v_sub_f32 v104, 1.0, v102
  v_sub_f32 v102, v102, v104
  .p2align 3
  v_pk_mul_f32 v[48:49], v[48:49], v[102:103] op_sel_hi:[1,0]
  v_pk_mul_f32 v[50:51], v[50:51], v[102:103] op_sel_hi:[1,0]
  v_pk_mul_f32 v[52:53], v[52:53], v[102:103] op_sel_hi:[1,0]
  v_pk_mul_f32 v[54:55], v[54:55], v[102:103] op_sel_hi:[1,0]
  v_pk_fma_f32 v[16:17], v[16:17], v[104:105], v[48:49] op_sel_hi:[1,0,1]
  v_pk_fma_f32 v[18:19], v[18:19], v[104:105], v[50:51] op_sel_hi:[1,0,1]
  v_pk_fma_f32 v[20:21], v[20:21], v[104:105], v[52:53] op_sel_hi:[1,0,1]
  v_pk_fma_f32 v[22:23], v[22:23], v[104:105], v[54:55] op_sel_hi:[1,0,1]
  v_cvt_pk_bf16_f32 v16, v16, v17
  v_cvt_pk_bf16_f32 v17, v18, v19
  v_cvt_pk_bf16_f32 v18, v20, v21
  v_cvt_pk_bf16_f32 v19, v22, v23
  s_nop 1
  v_permlane16_swap_b32 v16, v18
  v_permlane16_swap_b32 v17, v19
  ds_write_b128 v106, v[16:19] offset:2048
  s_waitcnt lgkmcnt(2)
  buffer_store_dwordx4 v[64:67], v109, s[28:31], s48 offen sc1
  s_add_u32 s48, s48, 16384
  s_waitcnt lgkmcnt(1)
  buffer_store_dwordx4 v[68:71], v109, s[28:31], s48 offen sc1
  s_add_u32 s48, s48, 16384
  .p2align 3
  v_pk_mul_f32 v[56:57], v[56:57], v[102:103] op_sel_hi:[1,0]
  v_pk_mul_f32 v[58:59], v[58:59], v[102:103] op_sel_hi:[1,0]
  v_pk_mul_f32 v[60:61], v[60:61], v[102:103] op_sel_hi:[1,0]
  v_pk_mul_f32 v[62:63], v[62:63], v[102:103] op_sel_hi:[1,0]
  v_pk_fma_f32 v[24:25], v[24:25], v[104:105], v[56:57] op_sel_hi:[1,0,1]
  v_pk_fma_f32 v[26:27], v[26:27], v[104:105], v[58:59] op_sel_hi:[1,0,1]
  v_pk_fma_f32 v[28:29], v[28:29], v[104:105], v[60:61] op_sel_hi:[1,0,1]
  v_pk_fma_f32 v[30:31], v[30:31], v[104:105], v[62:63] op_sel_hi:[1,0,1]
  v_cvt_pk_bf16_f32 v24, v24, v25
  v_cvt_pk_bf16_f32 v25, v26, v27
  v_cvt_pk_bf16_f32 v26, v28, v29
  v_cvt_pk_bf16_f32 v27, v30, v31
  s_nop 1
  v_permlane16_swap_b32 v24, v26
  v_permlane16_swap_b32 v25, v27
  ds_write_b128 v107, v[24:27] offset:2048
  ds_read_b128 v[72:75], v108 offset:2048
  ds_read_b128 v[76:79], v108 offset:3072
  s_waitcnt lgkmcnt(1)
  buffer_store_dwordx4 v[72:75], v109, s[28:31], s48 offen sc1
  s_add_u32 s48, s48, 16384
  s_waitcnt lgkmcnt(0)
  buffer_store_dwordx4 v[76:79], v109, s[28:31], s48 offen sc1
  s_add_u32 s48, s48, 16384
L1_end:
  s_endpgm
L_producer:
  v_mov_b32 v7, 0x7f000000
  s_add_u32 s62, s46, 1

  v_and_b32 v4, 31, v0
  s_mul_i32 s47, s41, 49152
  s_and_b32 s48, s42, 14
  s_lshl_b32 s48, s48, 7
  s_add_u32 s47, s47, s48
  v_lshl_add_u32 v5, v4, 11, s47
  v_lshrrev_b32 v6, 5, v0
  v_lshl_add_u32 v5, v6, 7, v5
  s_add_u32 s48, s46, s42
  s_or_b32 s48, s48, s43
  s_bitcmp0_b32 s48, 0

  s_cselect_b32 s93, -1, 0
  s_and_b32 vcc_lo, s93, 0xffffff
  s_mov_b32 vcc_hi, vcc_lo
  v_cndmask_b32 v30, v7, v5, vcc
  v_and_b32 v4, 7, v0
  v_bfe_u32 v5, v0, 3, 2
  v_lshl_add_u32 v4, v5, 6, v4
  s_and_b32 s48, s2, 231
  s_lshl_b32 s48, s48, 3
  v_add_u32 v4, s48, v4
  v_lshlrev_b32 v4, 11, v4
  s_and_b32 vcc_lo, s93, -1
  s_mov_b32 vcc_hi, 0
  v_cndmask_b32 v31, v7, v4, vcc

  s_cmp_eq_u32 s43, 0
  s_cselect_b32 s64, s12, s6
  s_cselect_b32 s65, s13, s7
  s_and_b32 s65, s65, 0xffff
  s_mov_b32 s66, 0x600000
  s_mov_b32 s67, 0x20000

  s_cmp_lt_u32 s46, 2
  s_cbranch_scc0 L_noearly
  s_add_u32 s62, s62, 4
L_noearly:
  s_getpc_b64 s[68:69]
L_pc:
  s_sub_u32 s68, s68, L_pc-gated_mix__linear_attn_block__sliding_block__prompt_kernel
  s_subb_u32 s69, s69, 0
  v_and_b32 v37, 7, v0
  s_lshl_b32 s48, s45, 3
  v_add_u32 v37, s48, v37
  v_lshlrev_b32 v37, 7, v37
  v_min_u32 v37, L_code_end-gated_mix__linear_attn_block__sliding_block__prompt_kernel-4, v37

  v_mov_b32 v48, 0
  v_mov_b32 v2, 147456
  ds_write_b32 v2, v48
  v_lshlrev_b32 v44, 4, v0
  v_mov_b32 v49, 0
  v_mov_b32 v50, 0
  v_mov_b32 v51, 0
  s_lshl_b32 s101, s42, 1
  s_add_u32 s101, s101, s43
  s_lshl_b32 s101, s101, 3
  v_mov_b32 v36, 1
  s_and_b32 s92, s41, 0
  s_add_u32 s92, s92, 1
  s_cmp_eq_u32 s46, 1
  s_cselect_b32 s92, s92, 99
  s_mov_b32 s57, 393216
  s_add_u32 s58, s55, 24576

  s_lshl_b32 s49, s43, 4
  s_add_u32 s49, s49, s42
  s_lshl_b32 s49, s49, 3
  s_add_u32 s49, s49, s41
  s_lshl_b32 s49, s49, 11
  s_add_u32 s63, s49, 23068672
  s_and_b32 s79, s45, 7
  s_xor_b32 s79, s79, 1
  s_bfe_u32 s77, s45, 0x10003
  s_and_b32 s49, s44, 1
  s_lshl_b32 s49, s49, 3
  s_add_u32 s79, s79, s49
  s_lshr_b32 s75, s45, 1
  s_and_b32 s75, s75, 0
  s_lshl_b32 s75, s75, 19
  s_lshr_b32 s78, s45, 4
  s_and_b32 s49, s44, 6
  s_add_u32 s78, s78, s49
  s_add_u32 s32, s22, 0
  s_addc_u32 s33, s23, 0
  s_and_b32 s33, s33, 0xffff
  s_mov_b32 s34, 27262976
  s_mov_b32 s35, 0x20000
  s_mov_b32 s36, s20
  s_and_b32 s37, s21, 0xffff
  s_mov_b32 s38, 256
  s_mov_b32 s39, 0x20000

  .p2align 3
  v_mov_b32 v244, 0xf149f2ca
  s_mov_b32 s64, 0xffffffff
  s_mov_b32 s65, 0xff00ff00
  v_cndmask_b32_e64 v120, v244, 0, s[64:65]
  v_cndmask_b32_e64 v136, 0, v244, s[64:65]
  s_mov_b32 s66, 0xfffffffe
  s_mov_b32 s67, 0xff00fe00
  v_cndmask_b32_e64 v121, v244, 0, s[66:67]
  v_cndmask_b32_e64 v137, 0, v244, s[66:67]
  s_mov_b32 s64, 0xfffffffc
  s_mov_b32 s65, 0xff00fc00
  v_cndmask_b32_e64 v122, v244, 0, s[64:65]
  v_cndmask_b32_e64 v138, 0, v244, s[64:65]
  s_mov_b32 s66, 0xfffffff8
  s_mov_b32 s67, 0xff00f800
  v_cndmask_b32_e64 v123, v244, 0, s[66:67]
  v_cndmask_b32_e64 v139, 0, v244, s[66:67]
  s_mov_b32 s64, 0xfffffff0
  s_mov_b32 s65, 0xff00f000
  v_cndmask_b32_e64 v124, v244, 0, s[64:65]
  v_cndmask_b32_e64 v140, 0, v244, s[64:65]
  s_mov_b32 s66, 0xffffffe0
  s_mov_b32 s67, 0xff00e000
  v_cndmask_b32_e64 v125, v244, 0, s[66:67]
  v_cndmask_b32_e64 v141, 0, v244, s[66:67]
  s_mov_b32 s64, 0xffffffc0
  s_mov_b32 s65, 0xff00c000
  v_cndmask_b32_e64 v126, v244, 0, s[64:65]
  v_cndmask_b32_e64 v142, 0, v244, s[64:65]
  s_mov_b32 s66, 0xffffff80
  s_mov_b32 s67, 0xff008000
  v_cndmask_b32_e64 v127, v244, 0, s[66:67]
  v_cndmask_b32_e64 v143, 0, v244, s[66:67]
  s_mov_b32 s64, 0xffffff00
  s_mov_b32 s65, 0xff000000
  v_cndmask_b32_e64 v128, v244, 0, s[64:65]
  v_cndmask_b32_e64 v144, 0, v244, s[64:65]
  s_mov_b32 s66, 0xfffeff00
  s_mov_b32 s67, 0xfe000000
  v_cndmask_b32_e64 v129, v244, 0, s[66:67]
  v_cndmask_b32_e64 v145, 0, v244, s[66:67]
  s_mov_b32 s64, 0xfffcff00
  s_mov_b32 s65, 0xfc000000
  v_cndmask_b32_e64 v130, v244, 0, s[64:65]
  v_cndmask_b32_e64 v146, 0, v244, s[64:65]
  s_mov_b32 s66, 0xfff8ff00
  s_mov_b32 s67, 0xf8000000
  v_cndmask_b32_e64 v131, v244, 0, s[66:67]
  v_cndmask_b32_e64 v147, 0, v244, s[66:67]
  s_mov_b32 s64, 0xfff0ff00
  s_mov_b32 s65, 0xf0000000
  v_cndmask_b32_e64 v132, v244, 0, s[64:65]
  v_cndmask_b32_e64 v148, 0, v244, s[64:65]
  s_mov_b32 s66, 0xffe0ff00
  s_mov_b32 s67, 0xe0000000
  v_cndmask_b32_e64 v133, v244, 0, s[66:67]
  v_cndmask_b32_e64 v149, 0, v244, s[66:67]
  s_mov_b32 s64, 0xffc0ff00
  s_mov_b32 s65, 0xc0000000
  v_cndmask_b32_e64 v134, v244, 0, s[64:65]
  v_cndmask_b32_e64 v150, 0, v244, s[64:65]
  s_mov_b32 s66, 0xff80ff00
  s_mov_b32 s67, 0x80000000
  v_cndmask_b32_e64 v135, v244, 0, s[66:67]
  v_cndmask_b32_e64 v151, 0, v244, s[66:67]
  v_bfe_u32 v244, v252, 2, 1
  v_mul_u32_u24 v154, 0x3f80, v244
  v_lshl_add_u32 v154, v154, 16, v154
  v_xor_b32 v152, 0x3f803f80, v154
  v_mov_b32 v155, v154
  v_mov_b32 v153, v152
  v_pk_mul_f32 v[64:65], 0, 0
  v_pk_mul_f32 v[66:67], 0, 0
  v_mov_b32 v242, 0xdddddddd
  v_and_b32 v157, 3, v252
  v_lshlrev_b32 v157, 4, v157
  v_lshl_add_u32 v157, v244, 10, v157
  v_lshrrev_b32 v244, 3, v252
  v_lshl_add_u32 v157, v244, 6, v157
  v_and_b32 v156, 7, v252
  v_lshlrev_b32 v156, 4, v156
  v_lshrrev_b32 v244, 4, v252
  v_lshl_add_u32 v156, v244, 7, v156
  v_bfe_u32 v244, v252, 3, 1
  v_lshl_add_u32 v156, v244, 10, v156
  s_and_b32 s46, s40, 1
  s_lshl_b32 s72, s46, 15
  s_and_b32 s46, s40, 2
  s_sub_u32 s70, 6, s46
  s_cmp_lt_u32 s40, 4
  s_cselect_b32 s70, s46, s70
  s_add_u32 s71, s70, 1
  s_lshl_b32 s46, s41, 5
  s_add_u32 s46, s46, s42
  s_lshl_b32 s46, s46, 1
  s_and_b32 s73, s40, 1
  s_add_u32 s46, s46, s73
  s_add_u32 s46, s46, 32
  s_mul_i32 s46, s46, 16384
  s_lshl_b32 s73, s70, 11
  s_add_u32 s73, s73, s46

  v_mfma_f32_32x32x16_bf16 v[72:87], v[64:67], v[64:67], 0
  v_mfma_f32_16x16x32_bf16 v[88:91], v[64:67], v[64:67], 0
  v_mfma_f32_32x32x16_bf16 v[100:115], v[64:67], v[64:67], 0
  v_mfma_f32_16x16x32_bf16 v[116:119], v[64:67], v[64:67], 0
  s_and_b32 s46, s40, 3
  s_cmp_eq_u32 s43, 0
  s_cselect_b32 s64, s12, s6
  s_cselect_b32 s65, s13, s7
  s_and_b32 s65, s65, 0xffff
  s_mov_b32 s66, 0x600000
  s_mov_b32 s67, 0x20000

  s_cmp_lt_u32 s46, 2
  s_cselect_b32 s96, s8, s14
  s_cselect_b32 s97, s9, s15
  s_and_b32 s97, s97, 0xffff
  s_mov_b32 s98, 0x200000
  s_mov_b32 s99, 0x20000
  s_and_b32 s100, s2, 231
  s_lshl_b32 s100, s100, 1
  s_and_b32 s48, s46, 1
  s_add_u32 s100, s100, s48
  s_lshl_b32 s100, s100, 12
  v_lshlrev_b32 v34, 7, v0
  v_cmp_gt_u32 vcc, 16, v0
  s_nop 1
  v_cndmask_b32 v34, v7, v34, vcc

  v_and_b32 v4, 15, v0
  v_lshlrev_b32 v4, 7, v4
  v_lshrrev_b32 v5, 4, v0
  v_lshl_add_u32 v4, v5, 16, v4
  s_cmp_eq_u32 s43, 2
  s_cselect_b32 vcc_lo, 0, s93

  s_mov_b32 vcc_hi, vcc_lo
  v_cndmask_b32 v34, v7, v4, vcc

  s_sub_u32 s46, s40, 4
  v_lshrrev_b32 v241, 3, v252
  v_xor_b32 v240, v241, v252
  v_and_b32 v240, 6, v240
  v_and_or_b32 v240, v252, 1, v240
  v_lshrrev_b32 v241, 3, v252
  v_lshlrev_b32 v240, 4, v240
  v_lshl_add_u32 v240, v241, 11, v240
  s_lshl_b32 s47, s79, 7
  s_lshl_b32 s48, s46, 15
  s_add_u32 s47, s47, s48
  v_add_u32 v240, s47, v240
  v_add_u32 v241, 15360, v240
  v_mov_b32 v224, 0
  s_lshl_b32 s91, s46, 11
  s_add_u32 s91, s91, 65536
  s_mov_b32 s80, s8
  s_and_b32 s81, s9, 0xffff
  s_mov_b32 s82, 0x200000
  s_mov_b32 s83, 0x20000
  s_mov_b32 s84, s14
  s_and_b32 s85, s15, 0xffff
  s_mov_b32 s86, 0x200000
  s_mov_b32 s87, 0x20000

  s_lshl_b32 s47, s46, 10
  s_add_u32 s47, s47, s63
  s_cmp_lt_u32 s46, 2
  s_cselect_b32 s47, s47, 0x10000000

  s_waitcnt lgkmcnt(0)
  s_barrier
  s_setprio 3

  buffer_store_dwordx4 v[48:51], v44, s[32:35], s47 offen sc1
  s_cmp_eq_u32 s43, 0
  s_cbranch_scc0 L_nosent
  s_lshl_b32 s47, s42, 3
  s_add_u32 s47, s47, s41
  s_lshl_b32 s47, s47, 2
  s_add_u32 s47, s47, s46
  s_lshl_b32 s47, s47, 12
  s_add_u32 s47, s47, 20971520
  v_mov_b32 v40, -1
  v_mov_b32 v41, -1
  v_mov_b32 v42, -1
  v_mov_b32 v43, -1
  buffer_store_dwordx4 v[40:43], v44, s[32:35], s47 offen sc1
  s_mov_b64 exec, 0xff
  buffer_store_dwordx4 v[40:43], v44, s[32:35], s47 offen offset:1024 sc1
  s_mov_b64 exec, -1

L_nosent:
  s_mov_b32 s56, 128
  s_add_u32 s59, s54, 32768
  s_add_u32 m0, s58, 0
  s_add_u32 s48, s57, 0
  buffer_load_dwordx4 v20, s[28:31], s48 offen  lds
  buffer_load_dwordx4 v21, s[28:31], s48 offen offset:1024  lds
  s_add_u32 m0, s58, 8192
  s_add_u32 s48, s57, 2048
  buffer_load_dwordx4 v20, s[28:31], s48 offen  lds
  buffer_load_dwordx4 v21, s[28:31], s48 offen offset:1024  lds
  s_add_u32 m0, s58, 16384
  s_add_u32 s48, s57, 4096
  buffer_load_dwordx4 v20, s[28:31], s48 offen  lds
  buffer_load_dwordx4 v21, s[28:31], s48 offen offset:1024  lds
  s_add_u32 m0, s59, 0
  s_add_u32 s48, s56, 0
  buffer_load_dwordx4 v10, s[24:27], s48 offen offset:0  lds
  buffer_load_dwordx4 v11, s[24:27], s48 offen offset:1024  lds
  buffer_load_dwordx4 v12, s[24:27], s48 offen offset:2048  lds
  buffer_load_dwordx4 v13, s[24:27], s48 offen offset:3072  lds
  s_add_u32 m0, s59, 4096
  s_add_u32 s48, s56, 65536
  buffer_load_dwordx4 v10, s[24:27], s48 offen offset:0  lds
  buffer_load_dwordx4 v11, s[24:27], s48 offen offset:1024  lds
  buffer_load_dwordx4 v12, s[24:27], s48 offen offset:2048  lds
  buffer_load_dwordx4 v13, s[24:27], s48 offen offset:3072  lds
  s_mov_b32 s57, 256
  s_add_u32 s58, s54, 65536
  s_waitcnt vmcnt(0)
  s_add_u32 m0, s58, 0
  s_add_u32 s48, s57, 0
  buffer_load_dwordx4 v10, s[24:27], s48 offen offset:0  lds
  buffer_load_dwordx4 v11, s[24:27], s48 offen offset:1024  lds
  buffer_load_dwordx4 v12, s[24:27], s48 offen offset:2048  lds
  buffer_load_dwordx4 v13, s[24:27], s48 offen offset:3072  lds
  s_add_u32 m0, s58, 4096
  s_add_u32 s48, s57, 65536
  buffer_load_dwordx4 v10, s[24:27], s48 offen offset:0  lds
  buffer_load_dwordx4 v11, s[24:27], s48 offen offset:1024  lds
  buffer_load_dwordx4 v12, s[24:27], s48 offen offset:2048  lds
  buffer_load_dwordx4 v13, s[24:27], s48 offen offset:3072  lds
  s_cmp_lt_u32 s46, 2
  s_cbranch_scc1 L_nolate0
  s_mul_i32 s60, s62, 393216
  s_lshl_b32 s61, s62, 7
  buffer_load_dword v32, v30, s[28:31], s60 offen
  buffer_load_dword v33, v31, s[24:27], s61 offen
  buffer_load_dword v32, v30, s[64:67], s60 offen
  s_add_u32 s62, s62, 4

L_nolate0:
  s_mov_b32 s50, 0
  s_mov_b32 s56, 786432
  s_mov_b32 s57, 384
  s_mov_b32 s58, s55
  s_mov_b32 s59, s54
  s_mov_b32 s51, 0

  s_cmp_lt_u32 s46, 2
  s_cbranch_scc1 L_nolate
  s_waitcnt vmcnt(11)
  s_branch L_late
L_nolate:
  s_waitcnt vmcnt(8)
L_late:
  s_barrier
L_prod:
  s_add_u32 m0, s58, 0
  s_add_u32 s48, s56, 0
  buffer_load_dwordx4 v20, s[28:31], s48 offen  lds
  buffer_load_dwordx4 v21, s[28:31], s48 offen offset:1024  lds
  s_add_u32 m0, s58, 8192
  s_add_u32 s48, s56, 2048
  buffer_load_dwordx4 v20, s[28:31], s48 offen  lds
  buffer_load_dwordx4 v21, s[28:31], s48 offen offset:1024  lds
  s_add_u32 m0, s58, 16384
  s_add_u32 s48, s56, 4096
  buffer_load_dwordx4 v20, s[28:31], s48 offen  lds
  buffer_load_dwordx4 v21, s[28:31], s48 offen offset:1024  lds
  s_add_u32 m0, s59, 0
  s_add_u32 s48, s57, 0
  buffer_load_dwordx4 v10, s[24:27], s48 offen offset:0  lds
  buffer_load_dwordx4 v11, s[24:27], s48 offen offset:1024  lds
  buffer_load_dwordx4 v12, s[24:27], s48 offen offset:2048  lds
  buffer_load_dwordx4 v13, s[24:27], s48 offen offset:3072  lds
  s_add_u32 m0, s59, 4096
  s_add_u32 s48, s57, 65536
  buffer_load_dwordx4 v10, s[24:27], s48 offen offset:0  lds
  buffer_load_dwordx4 v11, s[24:27], s48 offen offset:1024  lds
  buffer_load_dwordx4 v12, s[24:27], s48 offen offset:2048  lds
  buffer_load_dwordx4 v13, s[24:27], s48 offen offset:3072  lds
  s_and_b32 s47, s50, 3
  s_cmp_eq_u32 s47, s46
  s_cbranch_scc0 L_notouch
  s_cmp_lt_u32 s62, 16
  s_cbranch_scc0 L_lateturn

  s_mul_i32 s60, s62, 393216
  s_lshl_b32 s61, s62, 7
  buffer_load_dword v32, v30, s[28:31], s60 offen
  buffer_load_dword v33, v31, s[24:27], s61 offen
  buffer_load_dword v32, v30, s[64:67], s60 offen
  s_add_u32 s62, s62, 4

  s_cmp_eq_u32 s50, 1
  s_cbranch_scc0 L_noatom
  s_mov_b64 exec, 1
  buffer_atomic_add v36, off, s[36:39], s101 sc1
  s_mov_b64 exec, -1
  s_branch L_three

L_noatom:
  s_sub_u32 s47, s50, 2
  s_cmp_lt_u32 s47, 8
  s_cselect_b32 s47, s100, 0x200000
  s_cselect_b32 s49, 2048, 0
  buffer_load_dword v35, v34, s[96:99], s47 offen
  s_add_u32 s100, s100, s49

L_three:
  s_waitcnt vmcnt(12)
  s_branch L_touched
L_lateturn:
  s_cmp_eq_u32 s50, 11
  s_cbranch_scc0 L_late12
  global_load_dword v38, v37, s[68:69]
  s_waitcnt vmcnt(9)
  s_branch L_touched
L_late12:
L_notouch:
  s_waitcnt vmcnt(8)
L_touched:
  s_cmp_ge_u32 s50, 9
  s_cbranch_scc1 L_wl
L_aback:

  s_add_u32 s56, s56, 393216
  s_add_u32 s57, s57, 128
  s_cmp_eq_u32 s58, s55
  s_cselect_b32 s58, 24576, 0
  s_add_u32 s58, s58, s55
  s_add_u32 s51, s51, 1
  s_cmp_eq_u32 s51, 3
  s_cselect_b32 s51, 0, s51
  s_lshl_b32 s59, s51, 15
  s_add_u32 s59, s59, s54
  s_add_u32 s50, s50, 1
  s_barrier

  s_cmp_lt_u32 s50, 13
  s_cbranch_scc1 L_prod
  s_mov_b64 exec, -1

  s_add_u32 m0, s58, 0
  s_add_u32 s48, s56, 0
  buffer_load_dwordx4 v20, s[28:31], s48 offen  lds
  buffer_load_dwordx4 v21, s[28:31], s48 offen offset:1024  lds
  s_add_u32 m0, s58, 8192
  s_add_u32 s48, s56, 2048
  buffer_load_dwordx4 v20, s[28:31], s48 offen  lds
  buffer_load_dwordx4 v21, s[28:31], s48 offen offset:1024  lds
  s_add_u32 m0, s58, 16384
  s_add_u32 s48, s56, 4096
  buffer_load_dwordx4 v20, s[28:31], s48 offen  lds
  buffer_load_dwordx4 v21, s[28:31], s48 offen offset:1024  lds
  s_lshl_b32 s47, s41, 1
  s_add_u32 s47, s47, s43
  s_lshl_b32 s47, s47, 4
  s_add_u32 s47, s47, s42
  s_lshl_b32 s47, s47, 2
  s_add_u32 s47, s47, s46
  s_lshl_b32 s48, s47, 12
  v_lshlrev_b32 v1, 5, v0
  s_mov_b32 s64, s16
  s_and_b32 s65, s17, 0xffff
  s_mov_b32 s66, 2048
  s_mov_b32 s67, 0x20000
  v_and_b32 v254, 31, v0
  v_lshlrev_b32 v254, 3, v254
  buffer_load_dwordx4 v[40:43], v1, s[64:67], 0 offen
  buffer_load_dwordx4 v[44:47], v1, s[64:67], 0 offen offset:16
  buffer_load_dwordx4 v[48:51], v1, s[24:27], s48 offen
  buffer_load_dwordx4 v[52:55], v1, s[24:27], s48 offen offset:16
  buffer_load_dwordx4 v[56:59], v1, s[24:27], s48 offen offset:2048
  buffer_load_dwordx4 v[60:63], v1, s[24:27], s48 offen offset:2064
  buffer_load_dword v253, v254, s[36:39], 0 offen sc1

  s_mov_b32 s93, s47
  s_mov_b32 s57, 1048576
  buffer_load_dwordx4 v[208:211], v240, s[84:87], s57 offen
  buffer_load_dwordx4 v[212:215], v241, s[84:87], s57 offen offset:1024

  s_mov_b32 s57, 1179648
  buffer_load_dwordx4 v[216:219], v240, s[84:87], s57 offen
  buffer_load_dwordx4 v[220:223], v241, s[84:87], s57 offen offset:1024

  s_mov_b32 s57, 1310720
  buffer_load_dwordx4 v[224:227], v240, s[84:87], s57 offen
  buffer_load_dwordx4 v[228:231], v241, s[84:87], s57 offen offset:1024

  s_mov_b32 s57, 1441792
  buffer_load_dwordx4 v[232:235], v240, s[84:87], s57 offen
  buffer_load_dwordx4 v[236:239], v241, s[84:87], s57 offen offset:1024

  s_waitcnt vmcnt(15)
  s_barrier
  s_mov_b32 s57, 262144
  buffer_load_dwordx4 v[160:163], v240, s[84:87], s57 offen
  buffer_load_dwordx4 v[164:167], v241, s[84:87], s57 offen offset:1024

  s_mov_b32 s57, 393216
  buffer_load_dwordx4 v[168:171], v240, s[84:87], s57 offen
  buffer_load_dwordx4 v[172:175], v241, s[84:87], s57 offen offset:1024

  s_mov_b32 s57, 524288
  buffer_load_dwordx4 v[176:179], v240, s[84:87], s57 offen
  buffer_load_dwordx4 v[180:183], v241, s[84:87], s57 offen offset:1024

  s_mov_b32 s57, 655360
  buffer_load_dwordx4 v[184:187], v240, s[84:87], s57 offen
  buffer_load_dwordx4 v[188:191], v241, s[84:87], s57 offen offset:1024

  s_mov_b32 s57, 786432
  buffer_load_dwordx4 v[192:195], v240, s[84:87], s57 offen
  buffer_load_dwordx4 v[196:199], v241, s[84:87], s57 offen offset:1024

  s_mov_b32 s57, 917504
  buffer_load_dwordx4 v[200:203], v240, s[84:87], s57 offen
  buffer_load_dwordx4 v[204:207], v241, s[84:87], s57 offen offset:1024

  s_mov_b32 s47, s93
  s_setprio 0
  s_waitcnt vmcnt(20)
  s_setprio 0
  s_barrier
  s_cmp_eq_u32 s43, 0
  s_cbranch_scc0 L_no15
L_no15:
  v_mov_b32 v6, 0
  v_mov_b32 v7, 0
  v_dot2c_f32_bf16 v6, v48, v40
  v_dot2c_f32_bf16 v7, v56, v40
  v_dot2c_f32_bf16 v6, v49, v41
  v_dot2c_f32_bf16 v7, v57, v41
  v_dot2c_f32_bf16 v6, v50, v42
  v_dot2c_f32_bf16 v7, v58, v42
  v_dot2c_f32_bf16 v6, v51, v43
  v_dot2c_f32_bf16 v7, v59, v43
  v_dot2c_f32_bf16 v6, v52, v44
  v_dot2c_f32_bf16 v7, v60, v44
  v_dot2c_f32_bf16 v6, v53, v45
  v_dot2c_f32_bf16 v7, v61, v45
  v_dot2c_f32_bf16 v6, v54, v46
  v_dot2c_f32_bf16 v7, v62, v46
  v_dot2c_f32_bf16 v6, v55, v47
  v_dot2c_f32_bf16 v7, v63, v47
  s_nop 2
  v_permlane32_swap_b32 v6, v7
  s_nop 1
  v_add_f32 v6, v6, v7
  v_mov_b32 v7, v6
  s_nop 1
  v_permlane16_swap_b32 v6, v7
  s_nop 1
  v_add_f32 v6, v6, v7

  s_nop 1
  v_add_f32_dpp v6, v6, v6 row_ror:8 row_mask:0xf bank_mask:0xf
  s_nop 1
  v_add_f32_dpp v6, v6, v6 row_ror:4 row_mask:0xf bank_mask:0xf
  s_nop 1
  v_add_f32_dpp v6, v6, v6 row_ror:2 row_mask:0xf bank_mask:0xf
  s_nop 1
  v_add_f32_dpp v6, v6, v6 row_ror:1 row_mask:0xf bank_mask:0xf
  v_mul_f32 v6, 0xbfb8aa3b, v6
  v_exp_f32 v6, v6
  v_lshlrev_b32 v7, 2, v252
  v_add_f32 v6, 1.0, v6
  v_rcp_f32 v6, v6
  s_lshl_b32 s47, s93, 8
  s_add_u32 s47, s47, 24117248
  buffer_store_dword v6, v7, s[32:35], s47 offen sc1
  s_mov_b32 s48, 20000

L_initpoll:
  v_cmp_gt_u32 vcc, 8, v253
  s_cbranch_vccz L_initdone
  s_sub_u32 s48, s48, 1
  s_cmp_eq_u32 s48, 0
  s_cbranch_scc1 L_initdone
  buffer_load_dword v253, v254, s[36:39], 0 offen sc1
  s_waitcnt vmcnt(0)
  s_branch L_initpoll

L_initdone:
  s_cmp_eq_u32 s43, 0
  s_cbranch_scc1 L_prodA
  s_barrier
  s_branch L_battn1
L_prodA:
  s_sub_u32 s46, s40, 4
  s_and_b32 s47, s46, 1
  s_lshr_b32 s48, s46, 1
  s_mul_i32 s49, s47, 6144
  s_mul_i32 s50, s48, 3072
  s_add_u32 s49, s49, s50
  v_lshlrev_b32 v242, 4, v252
  v_add_u32 v243, s49, v242
  s_mul_i32 s49, s47, 3072
  s_add_u32 s49, s49, 32768
  s_lshl_b32 s50, s48, 10
  s_add_u32 s50, s50, s49
  v_add_u32 v244, s50, v242
  s_lshl_b32 s50, s48, 3
  s_add_u32 s50, s50, s49
  v_add_u32 v245, s50, v242
  v_and_b32 v246, 48, v252
  v_and_b32 v247, 7, v252
  v_lshl_add_u32 v247, v247, 14, v246
  v_and_b32 v6, 3, v252
  v_sub_u32 v246, v243, v242
  v_lshl_add_u32 v246, v6, 8, v246
  s_lshl_b32 s51, s42, 5
  s_add_u32 s51, s51, s46
  s_lshl_b32 s51, s51, 12
  s_add_u32 s51, s51, 20971520
  s_lshl_b32 s52, s41, 14
  s_add_u32 s52, s52, s51
  v_mov_b32 v0, 0
  v_mov_b32 v1, 0
  v_mov_b32 v4, 0
  v_mov_b32 v5, 0
  v_and_b32 v6, 1, v252
  v_lshlrev_b32 v6, 4, v6
  v_mov_b32 v7, 0x3f80
  v_lshlrev_b32 v6, v6, v7
  s_mov_b32 vcc_lo, 0x00300003
  s_mov_b32 vcc_hi, 0x30000300
  v_cndmask_b32 v2, 0, v6, vcc
  s_mov_b32 vcc_lo, 0x00c0000c
  s_mov_b32 vcc_hi, 0xc0000c00
  v_cndmask_b32 v3, 0, v6, vcc
  s_setprio 2
  s_barrier

  ds_read_b128 v[16:19], v243 offset:0
  ds_read_b128 v[28:31], v243 offset:12288
  ds_read_b128 v[20:23], v243 offset:1024
  ds_read_b128 v[32:35], v243 offset:13312
  ds_read_b128 v[24:27], v246 offset:2048
  ds_read_b128 v[36:39], v246 offset:14336
  s_waitcnt lgkmcnt(2)
  v_pk_add_f32 v[16:17], v[16:17], v[28:29]
  v_pk_add_f32 v[18:19], v[18:19], v[30:31]
  v_pk_add_f32 v[20:21], v[20:21], v[32:33]
  v_pk_add_f32 v[22:23], v[22:23], v[34:35]
  v_cvt_pk_bf16_f32 v8, v16, v17
  v_cvt_pk_bf16_f32 v9, v18, v19
  v_cvt_pk_bf16_f32 v10, v20, v21
  v_cvt_pk_bf16_f32 v11, v22, v23
  buffer_store_dwordx4 v[8:11], v242, s[32:35], s52 offen sc1
  s_waitcnt lgkmcnt(0)
  v_pk_add_f32 v[12:13], v[24:25], v[36:37]
  v_pk_add_f32 v[14:15], v[26:27], v[38:39]
  s_mov_b32 s48, 2500
  s_mov_b64 exec, 0xff
  buffer_store_dwordx4 v[12:15], v242, s[32:35], s52 offen offset:1024 sc1
  s_mov_b64 exec, -1

  s_mov_b32 s49, 8
  s_mov_b32 s90, 0
L_fillA1:
  s_lshl_b32 s57, s90, 17
  s_xor_b32 s57, s57, s75
  s_mov_b32 m0, s91
  s_add_u32 s91, s91, 8192
  s_add_u32 s90, s90, 1
  buffer_load_dwordx4 v240, s[80:83], s57 offen lds
  buffer_load_dwordx4 v241, s[80:83], s57 offen offset:1024 lds

  s_sub_u32 s49, s49, 1
  s_cmp_lg_u32 s49, 0
  s_cbranch_scc1 L_fillA1

  s_waitcnt vmcnt(16)
L_agather:
  buffer_load_dwordx4 v[248:251], v247, s[32:35], s51 offen offset:1024 sc1
  s_mov_b32 s53, s51
  buffer_load_dwordx4 v[16:19], v242, s[32:35], s53 offen sc1
  s_add_u32 s53, s53, 16384
  buffer_load_dwordx4 v[20:23], v242, s[32:35], s53 offen sc1
  s_add_u32 s53, s53, 16384
  buffer_load_dwordx4 v[24:27], v242, s[32:35], s53 offen sc1
  s_add_u32 s53, s53, 16384
  buffer_load_dwordx4 v[28:31], v242, s[32:35], s53 offen sc1
  s_add_u32 s53, s53, 16384
  buffer_load_dwordx4 v[32:35], v242, s[32:35], s53 offen sc1
  s_add_u32 s53, s53, 16384
  buffer_load_dwordx4 v[36:39], v242, s[32:35], s53 offen sc1
  s_add_u32 s53, s53, 16384
  buffer_load_dwordx4 v[40:43], v242, s[32:35], s53 offen sc1
  s_add_u32 s53, s53, 16384
  buffer_load_dwordx4 v[44:47], v242, s[32:35], s53 offen sc1
  s_waitcnt vmcnt(8)
  v_add_f32_dpp v248, v248, v248 row_ror:4 row_mask:0xf bank_mask:0xf
  v_add_f32_dpp v249, v249, v249 row_ror:4 row_mask:0xf bank_mask:0xf
  v_add_f32_dpp v250, v250, v250 row_ror:4 row_mask:0xf bank_mask:0xf
  v_add_f32_dpp v251, v251, v251 row_ror:4 row_mask:0xf bank_mask:0xf
  v_add_f32_dpp v248, v248, v248 row_ror:2 row_mask:0xf bank_mask:0xf
  v_add_f32_dpp v249, v249, v249 row_ror:2 row_mask:0xf bank_mask:0xf
  v_add_f32_dpp v250, v250, v250 row_ror:2 row_mask:0xf bank_mask:0xf
  v_add_f32_dpp v251, v251, v251 row_ror:2 row_mask:0xf bank_mask:0xf
  v_add_f32_dpp v248, v248, v248 row_ror:1 row_mask:0xf bank_mask:0xf
  v_add_f32_dpp v249, v249, v249 row_ror:1 row_mask:0xf bank_mask:0xf
  v_add_f32_dpp v250, v250, v250 row_ror:1 row_mask:0xf bank_mask:0xf
  v_add_f32_dpp v251, v251, v251 row_ror:1 row_mask:0xf bank_mask:0xf
  s_waitcnt vmcnt(7)
  v_mfma_f32_16x16x32_bf16 v[8:11], v[2:5], v[16:19], 0
  v_mfma_f32_16x16x32_bf16 v[12:15], v[0:3], v[16:19], 0
  s_waitcnt vmcnt(6)
  v_mfma_f32_16x16x32_bf16 v[8:11], v[2:5], v[20:23], v[8:11]
  v_mfma_f32_16x16x32_bf16 v[12:15], v[0:3], v[20:23], v[12:15]
  s_waitcnt vmcnt(5)
  v_mfma_f32_16x16x32_bf16 v[8:11], v[2:5], v[24:27], v[8:11]
  v_mfma_f32_16x16x32_bf16 v[12:15], v[0:3], v[24:27], v[12:15]
  s_waitcnt vmcnt(4)
  v_mfma_f32_16x16x32_bf16 v[8:11], v[2:5], v[28:31], v[8:11]
  v_mfma_f32_16x16x32_bf16 v[12:15], v[0:3], v[28:31], v[12:15]
  s_waitcnt vmcnt(3)
  v_mfma_f32_16x16x32_bf16 v[8:11], v[2:5], v[32:35], v[8:11]
  v_mfma_f32_16x16x32_bf16 v[12:15], v[0:3], v[32:35], v[12:15]
  s_waitcnt vmcnt(2)
  v_mfma_f32_16x16x32_bf16 v[8:11], v[2:5], v[36:39], v[8:11]
  v_mfma_f32_16x16x32_bf16 v[12:15], v[0:3], v[36:39], v[12:15]
  s_waitcnt vmcnt(1)
  v_mfma_f32_16x16x32_bf16 v[8:11], v[2:5], v[40:43], v[8:11]
  v_mfma_f32_16x16x32_bf16 v[12:15], v[0:3], v[40:43], v[12:15]
  s_waitcnt vmcnt(0)
  v_mfma_f32_16x16x32_bf16 v[8:11], v[2:5], v[44:47], v[8:11]
  v_mfma_f32_16x16x32_bf16 v[12:15], v[0:3], v[44:47], v[12:15]
  v_pk_add_f32 v[6:7], v[248:249], v[250:251]
  v_add_f32 v6, v6, v7
  v_cvt_pk_bf16_f32 v248, v248, v249
  v_cvt_pk_bf16_f32 v249, v250, v251
  s_nop 3
  v_cmp_u_f32 vcc, v6, v12
  s_cbranch_vccz L_apoll_d

L_apoll:
  s_sub_u32 s48, s48, 1
  s_cmp_eq_u32 s48, 0
  s_cbranch_scc1 L_apoll_d
  buffer_load_dword v7, v247, s[32:35], s51 offen offset:1024 sc1
  s_waitcnt vmcnt(0)
  v_cmp_eq_u32 vcc, -1, v7
  s_cbranch_vccnz L_apoll
  s_branch L_agather

L_apoll_d:
  v_cvt_pk_bf16_f32 v8, v8, v9
  v_cvt_pk_bf16_f32 v9, v10, v11
  v_cvt_pk_bf16_f32 v10, v12, v13
  v_cvt_pk_bf16_f32 v11, v14, v15
  ds_write_b64 v245, v[248:249] offset:2048
  ds_write_b128 v244, v[8:11]
  s_waitcnt lgkmcnt(0)

  s_barrier
  s_setprio 0
  s_barrier
  s_mov_b32 s49, 4
  s_mov_b32 s90, 8
L_fillA:
  s_lshl_b32 s57, s90, 17
  s_xor_b32 s57, s57, s75
  s_mov_b32 m0, s91
  s_add_u32 s91, s91, 8192
  s_add_u32 s90, s90, 1
  buffer_load_dwordx4 v240, s[80:83], s57 offen lds
  buffer_load_dwordx4 v241, s[80:83], s57 offen offset:1024 lds

  s_sub_u32 s49, s49, 1
  s_cmp_lg_u32 s49, 0
  s_cbranch_scc1 L_fillA

  s_branch L_fprodA
L_fprod:
  s_setprio 0
  s_waitcnt vmcnt(4)
  s_mov_b32 s57, 1572864
  buffer_load_dwordx4 v[112:115], v240, s[80:83], s57 offen
  buffer_load_dwordx4 v[116:119], v241, s[80:83], s57 offen offset:1024

  s_mov_b32 s57, 1703936
  buffer_load_dwordx4 v[120:123], v240, s[80:83], s57 offen
  buffer_load_dwordx4 v[124:127], v241, s[80:83], s57 offen offset:1024

  s_mov_b32 s57, 1835008
  buffer_load_dwordx4 v[128:131], v240, s[80:83], s57 offen
  buffer_load_dwordx4 v[132:135], v241, s[80:83], s57 offen offset:1024

  s_mov_b32 s57, 1966080
  buffer_load_dwordx4 v[136:139], v240, s[80:83], s57 offen
  buffer_load_dwordx4 v[140:143], v241, s[80:83], s57 offen offset:1024

  s_mov_b32 s57, 0
  buffer_load_dwordx4 v[144:147], v240, s[84:87], s57 offen
  buffer_load_dwordx4 v[148:151], v241, s[84:87], s57 offen offset:1024

  s_mov_b32 s57, 131072
  buffer_load_dwordx4 v[152:155], v240, s[84:87], s57 offen
  buffer_load_dwordx4 v[156:159], v241, s[84:87], s57 offen offset:1024

L_fprodA:
  s_cmp_eq_u32 s43, 0
  s_cbranch_scc0 L_nowaitfill
  s_waitcnt vmcnt(0)
L_nowaitfill:
  s_sub_u32 s47, s40, 4
  s_lshl_b32 s58, s47, 11
  v_lshlrev_b32 v10, 4, v252
  v_add_u32 v10, s58, v10
  v_add_u32 v11, 65536, v10
  v_add_u32 v12, 131072, v10

  s_cmp_lg_u32 s40, 6
  s_cbranch_scc1 L_gatedA
  s_mov_b32 s48, 20000
  v_and_b32 v248, 15, v252
  v_lshlrev_b32 v248, 14, v248
  v_lshrrev_b32 v244, 4, v252
  v_lshl_add_u32 v248, v244, 7, v248
  s_lshl_b32 s76, s78, 11
  s_add_u32 s76, s76, 23068672

  s_branch L_gate_eA
L_gateA:
L_gate_eA:
  buffer_load_dword v244, v248, s[32:35], s76 offen offset:1024 sc1
  s_sub_u32 s48, s48, 1
  s_cmp_eq_u32 s48, 0
  s_cbranch_scc1 L_gatedA
  s_waitcnt vmcnt(0)
  v_cmp_ne_u32 vcc, 1, v244
  s_cbranch_vccnz L_gateA

L_gatedA:
  s_barrier
  s_waitcnt vmcnt(0)
  ds_write_b128 v10, v[112:115] offset:0
  ds_write_b128 v10, v[116:119] offset:1024
  ds_write_b128 v10, v[120:123] offset:8192
  ds_write_b128 v10, v[124:127] offset:9216
  ds_write_b128 v10, v[128:131] offset:16384
  ds_write_b128 v10, v[132:135] offset:17408
  ds_write_b128 v10, v[136:139] offset:24576
  ds_write_b128 v10, v[140:143] offset:25600
  ds_write_b128 v10, v[144:147] offset:32768
  ds_write_b128 v10, v[148:151] offset:33792
  ds_write_b128 v10, v[152:155] offset:40960
  ds_write_b128 v10, v[156:159] offset:41984
  ds_write_b128 v10, v[160:163] offset:49152
  ds_write_b128 v10, v[164:167] offset:50176
  ds_write_b128 v10, v[168:171] offset:57344
  ds_write_b128 v10, v[172:175] offset:58368
  s_waitcnt lgkmcnt(0)
  s_barrier
  s_cmp_lg_u32 s40, 4
  s_cbranch_scc1 L_noflag1
  s_setprio 3
  s_lshl_b32 s46, s40, 7
  s_add_u32 s46, s46, s63
  v_mov_b32 v250, 1
  v_lshlrev_b32 v251, 2, v252
  s_mov_b32 exec_hi, 0

  buffer_store_dword v250, v251, s[32:35], s46 offen offset:1024 sc1
  s_mov_b32 exec_hi, -1

  s_setprio 0
L_noflag1:
  ds_write_b128 v11, v[176:179] offset:0
  ds_write_b128 v11, v[180:183] offset:1024
  ds_write_b128 v11, v[184:187] offset:8192
  ds_write_b128 v11, v[188:191] offset:9216
  ds_write_b128 v11, v[192:195] offset:16384
  ds_write_b128 v11, v[196:199] offset:17408
  ds_write_b128 v11, v[200:203] offset:24576
  ds_write_b128 v11, v[204:207] offset:25600
  s_waitcnt lgkmcnt(0)
  s_barrier
  ds_write_b128 v11, v[208:211] offset:32768
  ds_write_b128 v11, v[212:215] offset:33792
  ds_write_b128 v11, v[216:219] offset:40960
  ds_write_b128 v11, v[220:223] offset:41984
  ds_write_b128 v11, v[224:227] offset:49152
  ds_write_b128 v11, v[228:231] offset:50176
  ds_write_b128 v11, v[232:235] offset:57344
  ds_write_b128 v11, v[236:239] offset:58368
  s_setprio 3
  s_cmp_lg_u32 s40, 6
  s_cbranch_scc1 L_gatedB
  s_mov_b32 s48, 20000
  v_and_b32 v248, 15, v252
  v_lshlrev_b32 v248, 14, v248
  v_mov_b32 v244, 4
  v_lshl_add_u32 v248, v244, 7, v248
  s_lshl_b32 s76, s78, 11
  s_add_u32 s76, s76, 23330816

  s_branch L_gate_eB
L_gateB:
L_gate_eB:
  buffer_load_dword v244, v248, s[32:35], s76 offen offset:1024 sc1
  s_sub_u32 s48, s48, 1
  s_cmp_eq_u32 s48, 0
  s_cbranch_scc1 L_gatedB
  s_waitcnt vmcnt(0)
  v_cmp_ne_u32 vcc, 1, v244
  s_cbranch_vccnz L_gateB

L_gatedB:
  s_setprio 0
  s_waitcnt lgkmcnt(0)
  s_barrier
  s_lshl_b32 s47, s78, 1
  s_add_u32 s47, s47, s77
  s_lshl_b32 s47, s47, 2
  s_add_u32 s47, s47, s40
  s_lshl_b32 s47, s47, 12
  s_add_u32 s47, s47, 24100864
  v_and_b32 v2, 31, v252
  v_lshlrev_b32 v1, 7, v2
  buffer_load_dword v3, v1, s[32:35], s47 offen sc1
  v_lshlrev_b32 v2, 2, v2
  s_lshl_b32 s47, s40, 7
  v_add_u32 v2, s47, v2

  s_add_u32 m0, s58, 131072
  s_mov_b32 s57, 1572864
  buffer_load_dwordx4 v240, s[84:87], s57 offen lds
  buffer_load_dwordx4 v241, s[84:87], s57 offen offset:1024 lds

  s_waitcnt lgkmcnt(0)
  s_barrier
  s_add_u32 m0, s58, 139264
  s_mov_b32 s57, 1703936
  buffer_load_dwordx4 v240, s[84:87], s57 offen lds
  buffer_load_dwordx4 v241, s[84:87], s57 offen offset:1024 lds

  s_add_u32 m0, s58, 147456
  s_mov_b32 s57, 1835008
  buffer_load_dwordx4 v240, s[84:87], s57 offen lds
  buffer_load_dwordx4 v241, s[84:87], s57 offen offset:1024 lds

  s_waitcnt lgkmcnt(0)
  s_barrier
  s_waitcnt vmcnt(0)
  ds_write_b32 v2, v3 offset:0
  s_add_u32 m0, s58, 155648
  s_mov_b32 s57, 1966080
  buffer_load_dwordx4 v240, s[84:87], s57 offen lds
  buffer_load_dwordx4 v241, s[84:87], s57 offen offset:1024 lds

  s_waitcnt lgkmcnt(0)
  s_barrier
  s_waitcnt vmcnt(0)
  s_waitcnt lgkmcnt(0)
  s_barrier
  s_waitcnt lgkmcnt(0)
  s_barrier
  s_endpgm
L_wl:
  s_cmp_eq_u32 s50, 9
  s_cbranch_scc0 L_wl1
  s_lshr_b32 s47, s45, 4
  s_lshl_b32 s47, s47, 2
  s_add_u32 s47, s47, s46
  s_cmp_eq_u32 s47, 6
  s_cbranch_scc0 L_noc31
  s_and_b32 s47, s45, 15
  s_lshl_b32 s47, s47, 17
  s_and_b32 s48, s44, 1
  s_lshl_b32 s48, s48, 10
  s_add_u32 s47, s47, s48
  v_lshlrev_b32 v39, 11, v0
  buffer_load_dword v35, v39, s[84:87], s47 offen offset:384
L_noc31:

  s_branch L_aback
L_wl1:
  s_cmp_eq_u32 s50, 10
  s_cbranch_scc0 L_wl2
  s_branch L_aback
L_wl2:
  s_cmp_eq_u32 s50, 11
  s_cbranch_scc0 L_wl3
  s_lshr_b32 s47, s45, 4
  s_lshl_b32 s47, s47, 2
  s_add_u32 s47, s47, s46
  s_cmp_eq_u32 s47, 0
  s_cbranch_scc0 L_noc30
  s_and_b32 s47, s45, 15
  s_lshl_b32 s47, s47, 17
  s_and_b32 s48, s44, 1
  s_lshl_b32 s48, s48, 10
  s_add_u32 s47, s47, s48
  v_lshlrev_b32 v39, 11, v0
  buffer_load_dword v35, v39, s[80:83], s47 offen offset:384
L_noc30:

  s_cmp_eq_u32 s43, 0
  s_cbranch_scc0 L_aback
  s_mov_b32 s47, 1966080
  buffer_load_dwordx4 v[136:139], v240, s[80:83], s47 offen
  buffer_load_dwordx4 v[140:143], v241, s[80:83], s47 offen offset:1024

  s_mov_b32 s47, 0
  buffer_load_dwordx4 v[144:147], v240, s[84:87], s47 offen
  buffer_load_dwordx4 v[148:151], v241, s[84:87], s47 offen offset:1024

  s_mov_b32 s47, 131072
  buffer_load_dwordx4 v[152:155], v240, s[84:87], s47 offen
  buffer_load_dwordx4 v[156:159], v241, s[84:87], s47 offen offset:1024

  s_branch L_aback
L_wl3:
  s_cmp_eq_u32 s43, 0
  s_cbranch_scc0 L_aback
  s_mov_b32 s47, 1572864
  buffer_load_dwordx4 v[112:115], v240, s[80:83], s47 offen
  buffer_load_dwordx4 v[116:119], v241, s[80:83], s47 offen offset:1024

  s_mov_b32 s47, 1703936
  buffer_load_dwordx4 v[120:123], v240, s[80:83], s47 offen
  buffer_load_dwordx4 v[124:127], v241, s[80:83], s47 offen offset:1024

  s_mov_b32 s47, 1835008
  buffer_load_dwordx4 v[128:131], v240, s[80:83], s47 offen
  buffer_load_dwordx4 v[132:135], v241, s[80:83], s47 offen offset:1024

  s_branch L_aback
L_code_end:

.section .rodata,"a"
.p2align 6
.amdhsa_kernel gated_mix__linear_attn_block__sliding_block__prompt_kernel
  .amdhsa_next_free_vgpr 256
  .amdhsa_next_free_sgpr 102
  .amdhsa_accum_offset 256
  .amdhsa_group_segment_fixed_size 0
  .amdhsa_kernarg_size 80
  .amdhsa_user_sgpr_count 2
  .amdhsa_user_sgpr_kernarg_segment_ptr 1
  .amdhsa_system_sgpr_workgroup_id_x 1
.end_amdhsa_kernel
```
